```python
import torch

def _softmax(x, axis=-1):
    return torch.softmax(x, dim=axis)
def _gelu(x):
    return torch.nn.functional.gelu(x, approximate="tanh")
def _silu(x):
    return torch.nn.functional.silu(x)
def _sigmoid(x):
    return torch.sigmoid(x)
def _layernorm(x, axis=-1, eps=1e-5):
    m = x.mean(dim=axis, keepdim=True)
    v = x.var(dim=axis, keepdim=True, unbiased=False)
    return (x - m) / torch.sqrt(v + eps)
def _scatter_add(tgt, idx, src, axis=0):
    return tgt.clone().index_add_(axis, idx, src)
def _segment_sum(src, seg, n):
    out = torch.zeros((n,) + src.shape[1:], dtype=src.dtype)
    return out.index_add_(0, seg, src)
def _pad(x, pw):
    flat = tuple(v for pair in reversed(pw) for v in pair)
    return torch.nn.functional.pad(x, flat)

kernel_name = 'sequential_preLN__compressed_kv_cla__dense_activation_gelu__prompt'

def setup_inputs():

    _w = (lambda a: (lambda t: t.to(torch.bfloat16) if t.is_floating_point() else t)(torch.as_tensor(a)))
    def _A_setup():
        B, H, Sq, Sk, D, M = 1, 32, 2048, 2048, 128, 512
        Dc = 4 * D
        return {
            "x": _w((lambda *s: torch.randn(*s, dtype=torch.bfloat16) * 0.05)(B, Sq, M)),
            "c_kv": _w((lambda *s: torch.randn(*s, dtype=torch.bfloat16) * 0.2)(B, Sk, Dc)),
            "w_q": _w((lambda *s: torch.randn(*s, dtype=torch.bfloat16) * 6.4)(M, H, D) * (M ** -0.5)),
            "w_uk": _w((lambda *s: torch.randn(*s, dtype=torch.bfloat16) * 12.8)(Dc, H, D) * (Dc ** -0.5)),
            "w_uv": _w((lambda *s: torch.randn(*s, dtype=torch.bfloat16) * 0.2)(Dc, H, D) * (Dc ** -0.5)),
            "w_o": _w((lambda *s: torch.randn(*s, dtype=torch.bfloat16) * 0.2)(H, D, M) * ((H * D) ** -0.5)),
        }
    _A_in = _A_setup()

    def _B_setup():
        B, S, D, F = 1, 2048, 512, 1376
        return {
            "x": _w((lambda *s: torch.randn(*s, dtype=torch.bfloat16) * 0.05)(B, S, D)),
            "w1": _w((lambda *s: torch.randn(*s, dtype=torch.bfloat16) * 0.4)(D, F) * (D ** -0.5)),
            "b1": _w((lambda *s: torch.randn(*s, dtype=torch.bfloat16) * 12.8)(F) * 0.01),
            "w2": _w((lambda *s: torch.randn(*s, dtype=torch.bfloat16) * 0.2)(F, D) * (F ** -0.5)),
            "b2": _w((lambda *s: torch.randn(*s, dtype=torch.bfloat16) * 1.6)(D) * 0.01),
        }
    _B_in = _B_setup()

    return {
        "A_x": _A_in["x"],
        "A_c_kv": _A_in["c_kv"],
        "A_w_q": _A_in["w_q"],
        "A_w_uk": _A_in["w_uk"],
        "A_w_uv": _A_in["w_uv"],
        "A_w_o": _A_in["w_o"],
        "B_x": _B_in["x"],
        "B_w1": _B_in["w1"],
        "B_b1": _B_in["b1"],
        "B_w2": _B_in["w2"],
        "B_b2": _B_in["b2"],
    }

def reference(A_x, A_c_kv, A_w_q, A_w_uk, A_w_uv, A_w_o, B_x, B_w1, B_b1, B_w2, B_b2):
    def _A_ref(x, c_kv, w_q, w_uk, w_uv, w_o):
        B, Sq, M = x.shape[0], x.shape[1], x.shape[2]
        Sk = c_kv.shape[1]
        H, D = w_q.shape[1], w_q.shape[2]
        q = torch.einsum("bqm,mhd->bhqd", x, w_q)
        k = torch.einsum("bkc,chd->bhkd", c_kv, w_uk)
        v = torch.einsum("bkc,chd->bhkd", c_kv, w_uv)
        scores = torch.einsum("bhqd,bhkd->bhqk", q, k) * (D ** -0.5)
        off = Sk - Sq
        qi = torch.arange(Sq)[:, None]
        kj = torch.arange(Sk)[None, :]
        cmask = kj <= (qi + off)
        scores = torch.where(cmask[None, None], scores, -1e9)
        p = _softmax(scores, axis=-1)
        ctx = torch.einsum("bhqk,bhkd->bhqd", p, v)
        return torch.einsum("bhqd,hdm->bqm", ctx, w_o)

    def _B_ref(x, w1, b1, w2, b2):
        h = torch.einsum("bsd,df->bsf", x, w1) + b1
        h = _gelu(h)
        return torch.einsum("bsf,fd->bsd", h, w2) + b2

    x = A_x
    h = x + _A_ref(_layernorm(x, axis=-1), A_c_kv, A_w_q, A_w_uk, A_w_uv, A_w_o)
    h2 = h + _B_ref(_layernorm(h, axis=-1), B_w1, B_b1, B_w2, B_b2)
    return h2
```

```asm
; @launch kernel=ln1_kernel grid=(512,1,1) block=(256,1,1) lds=0
; @launch kernel=qkv_kernel grid=(1536,1,1) block=(256,1,1) lds=65536
; @launch kernel=attn_kernel grid=(512,1,1) block=(256,1,1) lds=65536
; @launch kernel=oproj_kernel grid=(256,1,1) block=(256,1,1) lds=131072
; @launch kernel=ln2_kernel grid=(512,1,1) block=(256,1,1) lds=0
; @launch kernel=ffn1_kernel grid=(176,1,1) block=(256,1,1) lds=131072
; @launch kernel=ffn2_kernel grid=(64,1,1) block=(256,1,1) lds=131072
.amdgcn_target "amdgcn-amd-amdhsa--gfx950"
.text
.globl ln1_kernel
.p2align 8
.type ln1_kernel,@function
ln1_kernel:
  s_cmp_ge_u32 s2, 512
  s_cbranch_scc1 L_ln1_kernel_done
  s_load_dwordx2 s[4:5], s[0:1], 0
  s_load_dwordx2 s[6:7], s[0:1], 104
  v_lshrrev_b32 v1, 6, v0
  v_and_b32 v2, 63, v0
  s_lshl_b32 s3, s2, 2
  v_add_u32 v1, s3, v1
  v_lshlrev_b32 v3, 10, v1
  v_lshl_add_u32 v3, v2, 4, v3
  s_waitcnt lgkmcnt(0)
  s_mov_b32 s8, s4
  s_and_b32 s9, s5, 0xffff
  s_mov_b32 s10, 2097152
  s_mov_b32 s11, 0x00020000
  s_add_u32 s20, s6, 0
  s_addc_u32 s21, s7, 0
  s_mov_b32 s12, s20
  s_and_b32 s13, s21, 0xffff
  s_mov_b32 s14, 2097152
  s_mov_b32 s15, 0x00020000
  buffer_load_dwordx4 v[4:7], v3, s[8:11], 0 offen
  s_waitcnt vmcnt(0)
  v_lshlrev_b32 v10, 16, v4
  v_and_b32 v11, 0xffff0000, v4
  v_lshlrev_b32 v12, 16, v5
  v_and_b32 v13, 0xffff0000, v5
  v_lshlrev_b32 v14, 16, v6
  v_and_b32 v15, 0xffff0000, v6
  v_lshlrev_b32 v16, 16, v7
  v_and_b32 v17, 0xffff0000, v7
  v_add_f32 v20, v10, v11
  v_add_f32 v20, v20, v12
  v_add_f32 v20, v20, v13
  v_add_f32 v20, v20, v14
  v_add_f32 v20, v20, v15
  v_add_f32 v20, v20, v16
  v_add_f32 v20, v20, v17
  ds_swizzle_b32 v21, v20 offset:0x41f
  s_waitcnt lgkmcnt(0)
  v_add_f32 v20, v20, v21
  ds_swizzle_b32 v21, v20 offset:0x81f
  s_waitcnt lgkmcnt(0)
  v_add_f32 v20, v20, v21
  ds_swizzle_b32 v21, v20 offset:0x101f
  s_waitcnt lgkmcnt(0)
  v_add_f32 v20, v20, v21
  ds_swizzle_b32 v21, v20 offset:0x201f
  s_waitcnt lgkmcnt(0)
  v_add_f32 v20, v20, v21
  ds_swizzle_b32 v21, v20 offset:0x401f
  s_waitcnt lgkmcnt(0)
  v_add_f32 v20, v20, v21
  v_mov_b32 v21, v20
  s_nop 1
  v_permlane32_swap_b32 v21, v20
  s_nop 1
  v_add_f32 v20, v20, v21
  v_mul_f32 v20, 0x3b000000, v20
  v_sub_f32 v24, v10, v20
  v_sub_f32 v25, v11, v20
  v_sub_f32 v26, v12, v20
  v_sub_f32 v27, v13, v20
  v_sub_f32 v28, v14, v20
  v_sub_f32 v29, v15, v20
  v_sub_f32 v30, v16, v20
  v_sub_f32 v31, v17, v20
  v_mul_f32 v22, v24, v24
  v_fmac_f32 v22, v25, v25
  v_fmac_f32 v22, v26, v26
  v_fmac_f32 v22, v27, v27
  v_fmac_f32 v22, v28, v28
  v_fmac_f32 v22, v29, v29
  v_fmac_f32 v22, v30, v30
  v_fmac_f32 v22, v31, v31
  ds_swizzle_b32 v21, v22 offset:0x41f
  s_waitcnt lgkmcnt(0)
  v_add_f32 v22, v22, v21
  ds_swizzle_b32 v21, v22 offset:0x81f
  s_waitcnt lgkmcnt(0)
  v_add_f32 v22, v22, v21
  ds_swizzle_b32 v21, v22 offset:0x101f
  s_waitcnt lgkmcnt(0)
  v_add_f32 v22, v22, v21
  ds_swizzle_b32 v21, v22 offset:0x201f
  s_waitcnt lgkmcnt(0)
  v_add_f32 v22, v22, v21
  ds_swizzle_b32 v21, v22 offset:0x401f
  s_waitcnt lgkmcnt(0)
  v_add_f32 v22, v22, v21
  v_mov_b32 v21, v22
  s_nop 1
  v_permlane32_swap_b32 v21, v22
  s_nop 1
  v_add_f32 v22, v22, v21
  v_mul_f32 v22, 0x3b000000, v22
  v_cvt_pk_bf16_f32 v23, v20, v22
  v_lshlrev_b32 v20, 16, v23
  v_and_b32 v22, 0xffff0000, v23
  v_add_f32 v22, 0x3727c5ac, v22
  v_cvt_pk_bf16_f32 v22, v22, v22
  v_lshlrev_b32 v22, 16, v22
  v_sqrt_f32 v22, v22
  s_nop 1
  v_cvt_pk_bf16_f32 v22, v22, v22
  v_lshlrev_b32 v22, 16, v22
  v_rcp_f32 v23, v22
  s_nop 1
  v_sub_f32 v24, v10, v20
  v_sub_f32 v25, v11, v20
  v_sub_f32 v26, v12, v20
  v_sub_f32 v27, v13, v20
  v_sub_f32 v28, v14, v20
  v_sub_f32 v29, v15, v20
  v_sub_f32 v30, v16, v20
  v_sub_f32 v31, v17, v20
  v_cvt_pk_bf16_f32 v32, v24, v25
  v_cvt_pk_bf16_f32 v33, v26, v27
  v_cvt_pk_bf16_f32 v34, v28, v29
  v_cvt_pk_bf16_f32 v35, v30, v31
  v_lshlrev_b32 v24, 16, v32
  v_and_b32 v25, 0xffff0000, v32
  v_lshlrev_b32 v26, 16, v33
  v_and_b32 v27, 0xffff0000, v33
  v_lshlrev_b32 v28, 16, v34
  v_and_b32 v29, 0xffff0000, v34
  v_lshlrev_b32 v30, 16, v35
  v_and_b32 v31, 0xffff0000, v35
  v_mul_f32 v32, v24, v23
  v_mul_f32 v33, v25, v23
  v_mul_f32 v34, v26, v23
  v_mul_f32 v35, v27, v23
  v_mul_f32 v36, v28, v23
  v_mul_f32 v37, v29, v23
  v_mul_f32 v38, v30, v23
  v_mul_f32 v39, v31, v23
  v_fma_f32 v10, -v32, v22, v24
  v_fma_f32 v11, -v33, v22, v25
  v_fma_f32 v12, -v34, v22, v26
  v_fma_f32 v13, -v35, v22, v27
  v_fma_f32 v14, -v36, v22, v28
  v_fma_f32 v15, -v37, v22, v29
  v_fma_f32 v16, -v38, v22, v30
  v_fma_f32 v17, -v39, v22, v31
  v_fmac_f32 v32, v10, v23
  v_fmac_f32 v33, v11, v23
  v_fmac_f32 v34, v12, v23
  v_fmac_f32 v35, v13, v23
  v_fmac_f32 v36, v14, v23
  v_fmac_f32 v37, v15, v23
  v_fmac_f32 v38, v16, v23
  v_fmac_f32 v39, v17, v23
  v_cvt_pk_bf16_f32 v4, v32, v33
  v_cvt_pk_bf16_f32 v5, v34, v35
  v_cvt_pk_bf16_f32 v6, v36, v37
  v_cvt_pk_bf16_f32 v7, v38, v39
  buffer_store_dwordx4 v[4:7], v3, s[12:15], 0 offen
L_ln1_kernel_done:
  s_endpgm
.section .rodata,"a"
.p2align 6
.amdhsa_kernel ln1_kernel
  .amdhsa_next_free_vgpr 72
  .amdhsa_next_free_sgpr 96
  .amdhsa_accum_offset 72
  .amdhsa_group_segment_fixed_size 0
  .amdhsa_kernarg_size 112
  .amdhsa_user_sgpr_count 2
  .amdhsa_user_sgpr_kernarg_segment_ptr 1
  .amdhsa_system_sgpr_workgroup_id_x 1
.end_amdhsa_kernel
.text
.globl qkv_kernel
.p2align 8
.type qkv_kernel,@function
qkv_kernel:
  s_cmp_ge_u32 s2, 1536
  s_cbranch_scc1 L_qkv_kernel_done
  s_load_dwordx4 s[32:35], s[0:1], 8
  s_load_dwordx4 s[36:39], s[0:1], 24
  s_load_dwordx2 s[40:41], s[0:1], 104
  s_and_b32 s16, s2, 31
  s_lshr_b32 s17, s2, 5
  s_and_b32 s17, s17, 15
  s_lshr_b32 s18, s2, 9
  s_waitcnt lgkmcnt(0)

  s_add_u32 s42, s40, 0
  s_addc_u32 s43, s41, 0
  s_cmp_eq_u32 s18, 0
  s_cselect_b32 s44, s42, s32
  s_cselect_b32 s45, s43, s33
  s_cselect_b32 s46, s34, s36
  s_cselect_b32 s47, s35, s37
  s_cmp_eq_u32 s18, 2
  s_cselect_b32 s46, s38, s46
  s_cselect_b32 s47, s39, s47
  s_lshl_b32 s19, s17, 17
  s_add_u32 s44, s44, s19
  s_addc_u32 s45, s45, 0

  s_mov_b32 s4, s44
  s_and_b32 s5, s45, 0xffff
  s_mov_b32 s6, 131072
  s_mov_b32 s7, 0x00020000
  s_lshl_b32 s19, s16, 8
  s_add_u32 s46, s46, s19
  s_addc_u32 s47, s47, 0
  s_sub_u32 s20, 4194304, s19

  s_mov_b32 s8, s46
  s_and_b32 s9, s47, 0xffff
  s_mov_b32 s10, s20
  s_mov_b32 s11, 0x00020000
  s_mul_i32 s20, s18, 0x1000000
  s_add_u32 s20, s20, 2097152
  s_lshl_b32 s21, s17, 20
  s_add_u32 s20, s20, s21
  s_add_u32 s20, s20, s19
  s_add_u32 s44, s40, s20
  s_addc_u32 s45, s41, 0

  s_mov_b32 s12, s44
  s_and_b32 s13, s45, 0xffff
  s_mov_b32 s14, 1048576
  s_mov_b32 s15, 0x00020000
  v_and_b32 v1, 63, v0
  v_lshrrev_b32 v2, 6, v0
  s_nop 1
  v_readfirstlane_b32 s50, v2
  v_lshrrev_b32 v5, 3, v1
  v_and_b32 v6, 7, v1
  v_lshrrev_b32 v7, 4, v1
  v_and_b32 v8, 1, v2
  v_lshl_add_u32 v8, v8, 2, v7
  v_xor_b32 v6, v6, v8
  v_mul_u32_u24 v3, 1024, v5
  v_lshl_add_u32 v3, v6, 4, v3
  v_and_b32 v6, 15, v1
  v_lshlrev_b32 v8, 2, v7
  v_xor_b32 v6, v6, v8
  v_mul_u32_u24 v4, 8192, v7
  v_lshl_add_u32 v4, v6, 4, v4

  v_and_b32 v1, 63, v0
  v_lshrrev_b32 v2, 6, v0
  v_lshrrev_b32 v7, 1, v2
  v_and_b32 v2, 1, v2
  v_and_b32 v8, 31, v1
  v_lshl_add_u32 v8, v7, 6, v8
  v_lshlrev_b32 v8, 7, v8
  v_lshrrev_b32 v9, 1, v1
  v_and_b32 v9, 7, v9
  v_lshrrev_b32 v10, 5, v1

  v_add_u32 v11, 0, v10
  v_xor_b32 v11, v11, v9
  v_lshl_add_u32 v12, v11, 4, v8

  v_add_u32 v11, 2, v10
  v_xor_b32 v11, v11, v9
  v_lshl_add_u32 v13, v11, 4, v8

  v_add_u32 v11, 4, v10
  v_xor_b32 v11, v11, v9
  v_lshl_add_u32 v14, v11, 4, v8

  v_add_u32 v11, 6, v10
  v_xor_b32 v11, v11, v9
  v_lshl_add_u32 v15, v11, 4, v8

  v_and_b32 v8, 15, v1
  v_lshrrev_b32 v9, 2, v8
  v_and_b32 v8, 3, v8
  v_lshrrev_b32 v7, 4, v1
  v_lshrrev_b32 v10, 1, v7
  v_lshlrev_b32 v10, 3, v10
  v_add_u32 v10, v10, v9
  v_lshlrev_b32 v10, 8, v10
  v_and_b32 v7, 1, v7
  v_lshlrev_b32 v7, 1, v7
  v_lshrrev_b32 v11, 1, v8
  v_add_u32 v7, v7, v11
  v_lshl_add_u32 v7, v2, 3, v7
  v_lshlrev_b32 v9, 2, v9
  v_and_b32 v8, 1, v8
  v_lshlrev_b32 v8, 3, v8
  v_add_u32 v10, v10, v8
  v_add_u32 v10, 16384, v10
  v_xor_b32 v11, v7, v9
  v_lshl_add_u32 v1, v11, 4, v10
  v_add_u32 v7, 4, v7
  v_xor_b32 v11, v7, v9
  v_lshl_add_u32 v2, v11, 4, v10
  v_mov_b32 v10, v1
  v_mov_b32 v11, v2

  v_add_u32 v144, 0x10000, v12
  v_add_u32 v145, 0x10000, v13
  v_add_u32 v146, 0x10000, v14
  v_add_u32 v147, 0x10000, v15
  v_add_u32 v148, 0x10000, v10
  v_add_u32 v149, 0x10000, v11
  v_mov_b32 v80, 0
  v_mov_b32 v81, 0
  v_mov_b32 v82, 0
  v_mov_b32 v83, 0
  v_mov_b32 v84, 0
  v_mov_b32 v85, 0
  v_mov_b32 v86, 0
  v_mov_b32 v87, 0
  v_mov_b32 v88, 0
  v_mov_b32 v89, 0
  v_mov_b32 v90, 0
  v_mov_b32 v91, 0
  v_mov_b32 v92, 0
  v_mov_b32 v93, 0
  v_mov_b32 v94, 0
  v_mov_b32 v95, 0
  v_mov_b32 v96, 0
  v_mov_b32 v97, 0
  v_mov_b32 v98, 0
  v_mov_b32 v99, 0
  v_mov_b32 v100, 0
  v_mov_b32 v101, 0
  v_mov_b32 v102, 0
  v_mov_b32 v103, 0
  v_mov_b32 v104, 0
  v_mov_b32 v105, 0
  v_mov_b32 v106, 0
  v_mov_b32 v107, 0
  v_mov_b32 v108, 0
  v_mov_b32 v109, 0
  v_mov_b32 v110, 0
  v_mov_b32 v111, 0
  v_mov_b32 v112, 0
  v_mov_b32 v113, 0
  v_mov_b32 v114, 0
  v_mov_b32 v115, 0
  v_mov_b32 v116, 0
  v_mov_b32 v117, 0
  v_mov_b32 v118, 0
  v_mov_b32 v119, 0
  v_mov_b32 v120, 0
  v_mov_b32 v121, 0
  v_mov_b32 v122, 0
  v_mov_b32 v123, 0
  v_mov_b32 v124, 0
  v_mov_b32 v125, 0
  v_mov_b32 v126, 0
  v_mov_b32 v127, 0
  v_mov_b32 v128, 0
  v_mov_b32 v129, 0
  v_mov_b32 v130, 0
  v_mov_b32 v131, 0
  v_mov_b32 v132, 0
  v_mov_b32 v133, 0
  v_mov_b32 v134, 0
  v_mov_b32 v135, 0
  v_mov_b32 v136, 0
  v_mov_b32 v137, 0
  v_mov_b32 v138, 0
  v_mov_b32 v139, 0
  v_mov_b32 v140, 0
  v_mov_b32 v141, 0
  v_mov_b32 v142, 0
  v_mov_b32 v143, 0
  s_mul_i32 s51, s50, 8192
  s_mul_i32 s52, s50, 32768
  s_add_u32 s24, s51, 0
  s_add_u32 s28, s52, 0
  s_add_u32 s25, s51, 32768
  s_add_u32 s29, s52, 131072
  s_add_u32 s26, s51, 65536
  s_add_u32 s30, s52, 262144
  s_add_u32 s27, s51, 98304
  s_add_u32 s31, s52, 393216
  s_lshl_b32 s53, s50, 10
  s_add_u32 m0, s53, 0
  s_nop 0
  buffer_load_dwordx4 v3, s[4:7], s24 offen lds
  s_add_u32 m0, s53, 4096
  s_nop 0
  buffer_load_dwordx4 v3, s[4:7], s25 offen lds
  s_add_u32 m0, s53, 8192
  s_nop 0
  buffer_load_dwordx4 v3, s[4:7], s26 offen lds
  s_add_u32 m0, s53, 12288
  s_nop 0
  buffer_load_dwordx4 v3, s[4:7], s27 offen lds
  s_add_u32 m0, s53, 16384
  s_nop 0
  buffer_load_dwordx4 v4, s[8:11], s28 offen lds
  s_add_u32 m0, s53, 20480
  s_nop 0
  buffer_load_dwordx4 v4, s[8:11], s29 offen lds
  s_add_u32 m0, s53, 24576
  s_nop 0
  buffer_load_dwordx4 v4, s[8:11], s30 offen lds
  s_add_u32 m0, s53, 28672
  s_nop 0
  buffer_load_dwordx4 v4, s[8:11], s31 offen lds
  s_add_u32 s24, s24, 128
  s_add_u32 s28, s28, 524288
  s_add_u32 s25, s25, 128
  s_add_u32 s29, s29, 524288
  s_add_u32 s26, s26, 128
  s_add_u32 s30, s30, 524288
  s_add_u32 s27, s27, 128
  s_add_u32 s31, s31, 524288
  s_mov_b32 s22, 4
L_qkv_kernel_loop:
  s_waitcnt vmcnt(0)
  s_barrier
  s_add_u32 m0, s53, 32768
  s_nop 0
  buffer_load_dwordx4 v3, s[4:7], s24 offen lds
  s_add_u32 m0, s53, 36864
  s_nop 0
  buffer_load_dwordx4 v3, s[4:7], s25 offen lds
  s_add_u32 m0, s53, 40960
  s_nop 0
  buffer_load_dwordx4 v3, s[4:7], s26 offen lds
  s_add_u32 m0, s53, 45056
  s_nop 0
  buffer_load_dwordx4 v3, s[4:7], s27 offen lds
  s_add_u32 m0, s53, 49152
  s_nop 0
  buffer_load_dwordx4 v4, s[8:11], s28 offen lds
  s_add_u32 m0, s53, 53248
  s_nop 0
  buffer_load_dwordx4 v4, s[8:11], s29 offen lds
  s_add_u32 m0, s53, 57344
  s_nop 0
  buffer_load_dwordx4 v4, s[8:11], s30 offen lds
  s_add_u32 m0, s53, 61440
  s_nop 0
  buffer_load_dwordx4 v4, s[8:11], s31 offen lds
  s_add_u32 s24, s24, 128
  s_add_u32 s28, s28, 524288
  s_add_u32 s25, s25, 128
  s_add_u32 s29, s29, 524288
  s_add_u32 s26, s26, 128
  s_add_u32 s30, s30, 524288
  s_add_u32 s27, s27, 128
  s_add_u32 s31, s31, 524288
  ds_read_b128 v[48:51], v12 offset:0
  ds_read_b128 v[52:55], v12 offset:4096
  ds_read_b64_tr_b16 v[56:57], v10 offset:0
  ds_read_b64_tr_b16 v[58:59], v10 offset:1024
  ds_read_b64_tr_b16 v[60:61], v11 offset:0
  ds_read_b64_tr_b16 v[62:63], v11 offset:1024
  ds_read_b128 v[64:67], v13 offset:0
  ds_read_b128 v[68:71], v13 offset:4096
  ds_read_b64_tr_b16 v[72:73], v10 offset:4096
  ds_read_b64_tr_b16 v[74:75], v10 offset:5120
  ds_read_b64_tr_b16 v[76:77], v11 offset:4096
  ds_read_b64_tr_b16 v[78:79], v11 offset:5120
  s_waitcnt lgkmcnt(6)
  v_mfma_f32_32x32x16_bf16 v[80:95], v[56:59], v[48:51], v[80:95]
  v_mfma_f32_32x32x16_bf16 v[96:111], v[56:59], v[52:55], v[96:111]
  v_mfma_f32_32x32x16_bf16 v[112:127], v[60:63], v[48:51], v[112:127]
  v_mfma_f32_32x32x16_bf16 v[128:143], v[60:63], v[52:55], v[128:143]
  ds_read_b128 v[48:51], v14 offset:0
  ds_read_b128 v[52:55], v14 offset:4096
  ds_read_b64_tr_b16 v[56:57], v10 offset:8192
  ds_read_b64_tr_b16 v[58:59], v10 offset:9216
  ds_read_b64_tr_b16 v[60:61], v11 offset:8192
  ds_read_b64_tr_b16 v[62:63], v11 offset:9216
  s_waitcnt lgkmcnt(6)
  v_mfma_f32_32x32x16_bf16 v[80:95], v[72:75], v[64:67], v[80:95]
  v_mfma_f32_32x32x16_bf16 v[96:111], v[72:75], v[68:71], v[96:111]
  v_mfma_f32_32x32x16_bf16 v[112:127], v[76:79], v[64:67], v[112:127]
  v_mfma_f32_32x32x16_bf16 v[128:143], v[76:79], v[68:71], v[128:143]
  ds_read_b128 v[64:67], v15 offset:0
  ds_read_b128 v[68:71], v15 offset:4096
  ds_read_b64_tr_b16 v[72:73], v10 offset:12288
  ds_read_b64_tr_b16 v[74:75], v10 offset:13312
  ds_read_b64_tr_b16 v[76:77], v11 offset:12288
  ds_read_b64_tr_b16 v[78:79], v11 offset:13312
  s_waitcnt lgkmcnt(6)
  v_mfma_f32_32x32x16_bf16 v[80:95], v[56:59], v[48:51], v[80:95]
  v_mfma_f32_32x32x16_bf16 v[96:111], v[56:59], v[52:55], v[96:111]
  v_mfma_f32_32x32x16_bf16 v[112:127], v[60:63], v[48:51], v[112:127]
  v_mfma_f32_32x32x16_bf16 v[128:143], v[60:63], v[52:55], v[128:143]
  s_waitcnt lgkmcnt(0)
  v_mfma_f32_32x32x16_bf16 v[80:95], v[72:75], v[64:67], v[80:95]
  v_mfma_f32_32x32x16_bf16 v[96:111], v[72:75], v[68:71], v[96:111]
  v_mfma_f32_32x32x16_bf16 v[112:127], v[76:79], v[64:67], v[112:127]
  v_mfma_f32_32x32x16_bf16 v[128:143], v[76:79], v[68:71], v[128:143]
  s_waitcnt vmcnt(0)
  s_barrier
  s_add_u32 m0, s53, 0
  s_nop 0
  buffer_load_dwordx4 v3, s[4:7], s24 offen lds
  s_add_u32 m0, s53, 4096
  s_nop 0
  buffer_load_dwordx4 v3, s[4:7], s25 offen lds
  s_add_u32 m0, s53, 8192
  s_nop 0
  buffer_load_dwordx4 v3, s[4:7], s26 offen lds
  s_add_u32 m0, s53, 12288
  s_nop 0
  buffer_load_dwordx4 v3, s[4:7], s27 offen lds
  s_add_u32 m0, s53, 16384
  s_nop 0
  buffer_load_dwordx4 v4, s[8:11], s28 offen lds
  s_add_u32 m0, s53, 20480
  s_nop 0
  buffer_load_dwordx4 v4, s[8:11], s29 offen lds
  s_add_u32 m0, s53, 24576
  s_nop 0
  buffer_load_dwordx4 v4, s[8:11], s30 offen lds
  s_add_u32 m0, s53, 28672
  s_nop 0
  buffer_load_dwordx4 v4, s[8:11], s31 offen lds
  s_add_u32 s24, s24, 128
  s_add_u32 s28, s28, 524288
  s_add_u32 s25, s25, 128
  s_add_u32 s29, s29, 524288
  s_add_u32 s26, s26, 128
  s_add_u32 s30, s30, 524288
  s_add_u32 s27, s27, 128
  s_add_u32 s31, s31, 524288
  ds_read_b128 v[48:51], v12 offset:32768
  ds_read_b128 v[52:55], v12 offset:36864
  ds_read_b64_tr_b16 v[56:57], v10 offset:32768
  ds_read_b64_tr_b16 v[58:59], v10 offset:33792
  ds_read_b64_tr_b16 v[60:61], v11 offset:32768
  ds_read_b64_tr_b16 v[62:63], v11 offset:33792
  ds_read_b128 v[64:67], v13 offset:32768
  ds_read_b128 v[68:71], v13 offset:36864
  ds_read_b64_tr_b16 v[72:73], v10 offset:36864
  ds_read_b64_tr_b16 v[74:75], v10 offset:37888
  ds_read_b64_tr_b16 v[76:77], v11 offset:36864
  ds_read_b64_tr_b16 v[78:79], v11 offset:37888
  s_waitcnt lgkmcnt(6)
  v_mfma_f32_32x32x16_bf16 v[80:95], v[56:59], v[48:51], v[80:95]
  v_mfma_f32_32x32x16_bf16 v[96:111], v[56:59], v[52:55], v[96:111]
  v_mfma_f32_32x32x16_bf16 v[112:127], v[60:63], v[48:51], v[112:127]
  v_mfma_f32_32x32x16_bf16 v[128:143], v[60:63], v[52:55], v[128:143]
  ds_read_b128 v[48:51], v14 offset:32768
  ds_read_b128 v[52:55], v14 offset:36864
  ds_read_b64_tr_b16 v[56:57], v10 offset:40960
  ds_read_b64_tr_b16 v[58:59], v10 offset:41984
  ds_read_b64_tr_b16 v[60:61], v11 offset:40960
  ds_read_b64_tr_b16 v[62:63], v11 offset:41984
  s_waitcnt lgkmcnt(6)
  v_mfma_f32_32x32x16_bf16 v[80:95], v[72:75], v[64:67], v[80:95]
  v_mfma_f32_32x32x16_bf16 v[96:111], v[72:75], v[68:71], v[96:111]
  v_mfma_f32_32x32x16_bf16 v[112:127], v[76:79], v[64:67], v[112:127]
  v_mfma_f32_32x32x16_bf16 v[128:143], v[76:79], v[68:71], v[128:143]
  ds_read_b128 v[64:67], v15 offset:32768
  ds_read_b128 v[68:71], v15 offset:36864
  ds_read_b64_tr_b16 v[72:73], v10 offset:45056
  ds_read_b64_tr_b16 v[74:75], v10 offset:46080
  ds_read_b64_tr_b16 v[76:77], v11 offset:45056
  ds_read_b64_tr_b16 v[78:79], v11 offset:46080
  s_waitcnt lgkmcnt(6)
  v_mfma_f32_32x32x16_bf16 v[80:95], v[56:59], v[48:51], v[80:95]
  v_mfma_f32_32x32x16_bf16 v[96:111], v[56:59], v[52:55], v[96:111]
  v_mfma_f32_32x32x16_bf16 v[112:127], v[60:63], v[48:51], v[112:127]
  v_mfma_f32_32x32x16_bf16 v[128:143], v[60:63], v[52:55], v[128:143]
  s_waitcnt lgkmcnt(0)
  v_mfma_f32_32x32x16_bf16 v[80:95], v[72:75], v[64:67], v[80:95]
  v_mfma_f32_32x32x16_bf16 v[96:111], v[72:75], v[68:71], v[96:111]
  v_mfma_f32_32x32x16_bf16 v[112:127], v[76:79], v[64:67], v[112:127]
  v_mfma_f32_32x32x16_bf16 v[128:143], v[76:79], v[68:71], v[128:143]
  s_sub_u32 s22, s22, 1
  s_cmp_lg_u32 s22, 0
  s_cbranch_scc1 L_qkv_kernel_loop
  s_waitcnt vmcnt(0)
  s_barrier
  s_nop 7
  s_nop 7
  v_and_b32 v9, 63, v0
  v_and_b32 v1, 31, v9
  v_lshrrev_b32 v2, 5, v9
  v_lshrrev_b32 v8, 6, v0
  v_lshrrev_b32 v7, 1, v8
  v_and_b32 v8, 1, v8

  v_lshl_add_u32 v3, v7, 6, v1
  v_mul_u32_u24 v3, 272, v3
  v_lshlrev_b32 v4, 3, v2
  v_lshl_add_u32 v4, v8, 7, v4
  v_add_u32 v3, v3, v4
  v_lshrrev_b32 v5, 4, v0
  v_and_b32 v6, 15, v0
  v_mul_u32_u24 v4, 272, v5
  v_lshl_add_u32 v4, v6, 4, v4
  v_mul_u32_u24 v5, 8192, v5
  v_lshl_add_u32 v5, v6, 4, v5

  v_cvt_pk_bf16_f32 v16, v80, v81
  v_cvt_pk_bf16_f32 v17, v82, v83
  ds_write_b64 v3, v[16:17] offset:0
  v_cvt_pk_bf16_f32 v16, v84, v85
  v_cvt_pk_bf16_f32 v17, v86, v87
  ds_write_b64 v3, v[16:17] offset:16
  v_cvt_pk_bf16_f32 v16, v88, v89
  v_cvt_pk_bf16_f32 v17, v90, v91
  ds_write_b64 v3, v[16:17] offset:32
  v_cvt_pk_bf16_f32 v16, v92, v93
  v_cvt_pk_bf16_f32 v17, v94, v95
  ds_write_b64 v3, v[16:17] offset:48
  v_cvt_pk_bf16_f32 v16, v96, v97
  v_cvt_pk_bf16_f32 v17, v98, v99
  ds_write_b64 v3, v[16:17] offset:8704
  v_cvt_pk_bf16_f32 v16, v100, v101
  v_cvt_pk_bf16_f32 v17, v102, v103
  ds_write_b64 v3, v[16:17] offset:8720
  v_cvt_pk_bf16_f32 v16, v104, v105
  v_cvt_pk_bf16_f32 v17, v106, v107
  ds_write_b64 v3, v[16:17] offset:8736
  v_cvt_pk_bf16_f32 v16, v108, v109
  v_cvt_pk_bf16_f32 v17, v110, v111
  ds_write_b64 v3, v[16:17] offset:8752
  v_cvt_pk_bf16_f32 v16, v112, v113
  v_cvt_pk_bf16_f32 v17, v114, v115
  ds_write_b64 v3, v[16:17] offset:64
  v_cvt_pk_bf16_f32 v16, v116, v117
  v_cvt_pk_bf16_f32 v17, v118, v119
  ds_write_b64 v3, v[16:17] offset:80
  v_cvt_pk_bf16_f32 v16, v120, v121
  v_cvt_pk_bf16_f32 v17, v122, v123
  ds_write_b64 v3, v[16:17] offset:96
  v_cvt_pk_bf16_f32 v16, v124, v125
  v_cvt_pk_bf16_f32 v17, v126, v127
  ds_write_b64 v3, v[16:17] offset:112
  v_cvt_pk_bf16_f32 v16, v128, v129
  v_cvt_pk_bf16_f32 v17, v130, v131
  ds_write_b64 v3, v[16:17] offset:8768
  v_cvt_pk_bf16_f32 v16, v132, v133
  v_cvt_pk_bf16_f32 v17, v134, v135
  ds_write_b64 v3, v[16:17] offset:8784
  v_cvt_pk_bf16_f32 v16, v136, v137
  v_cvt_pk_bf16_f32 v17, v138, v139
  ds_write_b64 v3, v[16:17] offset:8800
  v_cvt_pk_bf16_f32 v16, v140, v141
  v_cvt_pk_bf16_f32 v17, v142, v143
  ds_write_b64 v3, v[16:17] offset:8816
  s_waitcnt lgkmcnt(0)
  s_barrier
  ds_read_b128 v[80:83], v4 offset:0
  ds_read_b128 v[84:87], v4 offset:4352
  ds_read_b128 v[88:91], v4 offset:8704
  ds_read_b128 v[92:95], v4 offset:13056
  ds_read_b128 v[96:99], v4 offset:17408
  ds_read_b128 v[100:103], v4 offset:21760
  ds_read_b128 v[104:107], v4 offset:26112
  ds_read_b128 v[108:111], v4 offset:30464
  s_mov_b32 s23, 0
  s_waitcnt lgkmcnt(7)
  buffer_store_dwordx4 v[80:83], v5, s[12:15], s23 offen
  s_mov_b32 s23, 131072
  s_waitcnt lgkmcnt(6)
  buffer_store_dwordx4 v[84:87], v5, s[12:15], s23 offen
  s_mov_b32 s23, 262144
  s_waitcnt lgkmcnt(5)
  buffer_store_dwordx4 v[88:91], v5, s[12:15], s23 offen
  s_mov_b32 s23, 393216
  s_waitcnt lgkmcnt(4)
  buffer_store_dwordx4 v[92:95], v5, s[12:15], s23 offen
  s_mov_b32 s23, 524288
  s_waitcnt lgkmcnt(3)
  buffer_store_dwordx4 v[96:99], v5, s[12:15], s23 offen
  s_mov_b32 s23, 655360
  s_waitcnt lgkmcnt(2)
  buffer_store_dwordx4 v[100:103], v5, s[12:15], s23 offen
  s_mov_b32 s23, 786432
  s_waitcnt lgkmcnt(1)
  buffer_store_dwordx4 v[104:107], v5, s[12:15], s23 offen
  s_mov_b32 s23, 917504
  s_waitcnt lgkmcnt(0)
  buffer_store_dwordx4 v[108:111], v5, s[12:15], s23 offen
L_qkv_kernel_done:
  s_endpgm
.section .rodata,"a"
.p2align 6
.amdhsa_kernel qkv_kernel
  .amdhsa_next_free_vgpr 152
  .amdhsa_next_free_sgpr 96
  .amdhsa_accum_offset 152
  .amdhsa_group_segment_fixed_size 0
  .amdhsa_kernarg_size 112
  .amdhsa_user_sgpr_count 2
  .amdhsa_user_sgpr_kernarg_segment_ptr 1
  .amdhsa_system_sgpr_workgroup_id_x 1
.end_amdhsa_kernel
.text
.globl attn_kernel
.p2align 8
.type attn_kernel,@function
attn_kernel:
  s_cmp_ge_u32 s2, 512
  s_cbranch_scc1 L_attn_kernel_done
  s_load_dwordx2 s[40:41], s[0:1], 104
  s_and_b32 s16, s2, 7
  s_lshr_b32 s17, s2, 3
  s_and_b32 s17, s17, 3
  s_lshl_b32 s17, s17, 3
  s_add_u32 s16, s16, s17
  s_lshr_b32 s17, s2, 5
  s_sub_u32 s18, 15, s17
  s_sub_u32 s19, s17, 8
  s_cmp_ge_u32 s17, 8
  s_cselect_b32 s17, s19, s18
  s_mov_b32 s62, 1
  s_lshl_b32 s20, s16, 8
  s_waitcnt lgkmcnt(0)
  s_add_u32 s42, s40, 2097152
  s_addc_u32 s43, s41, 0
  s_add_u32 s42, s42, s20
  s_addc_u32 s43, s43, 0

  s_mov_b32 s4, s42
  s_and_b32 s5, s43, 0xffff
  s_mov_b32 s6, 16777216
  s_mov_b32 s7, 0x00020000
  s_add_u32 s42, s40, 18874368
  s_addc_u32 s43, s41, 0
  s_add_u32 s42, s42, s20
  s_addc_u32 s43, s43, 0

  s_mov_b32 s8, s42
  s_and_b32 s9, s43, 0xffff
  s_mov_b32 s10, 16777216
  s_mov_b32 s11, 0x00020000
  s_add_u32 s42, s40, 35651584
  s_addc_u32 s43, s41, 0
  s_add_u32 s42, s42, s20
  s_addc_u32 s43, s43, 0

  s_mov_b32 s12, s42
  s_and_b32 s13, s43, 0xffff
  s_mov_b32 s14, 16777216
  s_mov_b32 s15, 0x00020000
  s_add_u32 s42, s40, 52428800
  s_addc_u32 s43, s41, 0
  s_add_u32 s42, s42, s20
  s_addc_u32 s43, s43, 0

  s_mov_b32 s44, s42
  s_and_b32 s45, s43, 0xffff
  s_mov_b32 s46, 16777216
  s_mov_b32 s47, 0x00020000
L_attn_kernel_blk:
  s_lshl_b32 s18, s17, 7
  s_add_u32 s19, s17, 1
  s_lshl_b32 s19, s19, 1

  v_and_b32 v1, 63, v0
  v_lshrrev_b32 v2, 6, v0
  v_and_b32 v3, 31, v1
  v_lshrrev_b32 v4, 5, v1
  v_lshl_add_u32 v5, v2, 5, v3
  v_add_u32 v5, s18, v5
  v_lshlrev_b32 v6, 13, v5
  v_lshl_add_u32 v6, v4, 4, v6

  buffer_load_dwordx4 v[32:35], v6, s[4:7], 0 offen offset:0
  buffer_load_dwordx4 v[36:39], v6, s[4:7], 0 offen offset:32
  buffer_load_dwordx4 v[40:43], v6, s[4:7], 0 offen offset:64
  buffer_load_dwordx4 v[44:47], v6, s[4:7], 0 offen offset:96
  buffer_load_dwordx4 v[48:51], v6, s[4:7], 0 offen offset:128
  buffer_load_dwordx4 v[52:55], v6, s[4:7], 0 offen offset:160
  buffer_load_dwordx4 v[56:59], v6, s[4:7], 0 offen offset:192
  buffer_load_dwordx4 v[60:63], v6, s[4:7], 0 offen offset:224
  s_nop 1
  v_readfirstlane_b32 s50, v2
  v_lshrrev_b32 v7, 4, v1
  v_and_b32 v8, 15, v1
  v_lshlrev_b32 v9, 13, v7
  v_lshl_add_u32 v12, v2, 2, v7
  v_and_b32 v12, 15, v12
  v_xor_b32 v12, v12, v8
  v_lshl_add_u32 v10, v12, 4, v9
  v_lshlrev_b32 v12, 2, v7
  v_xor_b32 v12, v12, v8
  v_lshl_add_u32 v11, v12, 4, v9
  s_lshl_b32 s53, s50, 10
  s_lshl_b32 s51, s50, 15

  v_and_b32 v12, 15, v1
  v_lshlrev_b32 v13, 8, v3

  v_add_u32 v14, 0, v4
  v_xor_b32 v14, v14, v12
  v_lshl_add_u32 v16, v14, 4, v13

  v_add_u32 v14, 2, v4
  v_xor_b32 v14, v14, v12
  v_lshl_add_u32 v17, v14, 4, v13

  v_add_u32 v14, 4, v4
  v_xor_b32 v14, v14, v12
  v_lshl_add_u32 v18, v14, 4, v13

  v_add_u32 v14, 6, v4
  v_xor_b32 v14, v14, v12
  v_lshl_add_u32 v19, v14, 4, v13

  v_add_u32 v14, 8, v4
  v_xor_b32 v14, v14, v12
  v_lshl_add_u32 v20, v14, 4, v13

  v_add_u32 v14, 10, v4
  v_xor_b32 v14, v14, v12
  v_lshl_add_u32 v21, v14, 4, v13

  v_add_u32 v14, 12, v4
  v_xor_b32 v14, v14, v12
  v_lshl_add_u32 v22, v14, 4, v13

  v_add_u32 v14, 14, v4
  v_xor_b32 v14, v14, v12
  v_lshl_add_u32 v23, v14, 4, v13

  v_and_b32 v12, 15, v1
  v_lshrrev_b32 v13, 2, v12
  v_and_b32 v12, 3, v12
  v_lshrrev_b32 v14, 4, v1
  v_lshrrev_b32 v15, 1, v14
  v_lshl_add_u32 v15, v15, 2, v13
  v_lshlrev_b32 v15, 8, v15
  v_and_b32 v14, 1, v14
  v_lshlrev_b32 v14, 1, v14
  v_lshrrev_b32 v7, 1, v12
  v_add_u32 v14, v14, v7
  v_and_b32 v12, 1, v12
  v_lshl_add_u32 v15, v12, 3, v15
  v_add_u32 v15, 16384, v15
  v_lshlrev_b32 v13, 2, v13

  v_add_u32 v7, 0, v14
  v_xor_b32 v7, v7, v13
  v_lshl_add_u32 v24, v7, 4, v15

  v_add_u32 v7, 4, v14
  v_xor_b32 v7, v7, v13
  v_lshl_add_u32 v25, v7, 4, v15

  v_add_u32 v7, 8, v14
  v_xor_b32 v7, v7, v13
  v_lshl_add_u32 v26, v7, 4, v15

  v_add_u32 v7, 12, v14
  v_xor_b32 v7, v7, v13
  v_lshl_add_u32 v27, v7, 4, v15

  v_mov_b32 v240, 0xff800000
  v_mov_b32 v241, 0
  v_mov_b32 v144, 0
  v_mov_b32 v145, 0
  v_mov_b32 v146, 0
  v_mov_b32 v147, 0
  v_mov_b32 v148, 0
  v_mov_b32 v149, 0
  v_mov_b32 v150, 0
  v_mov_b32 v151, 0
  v_mov_b32 v152, 0
  v_mov_b32 v153, 0
  v_mov_b32 v154, 0
  v_mov_b32 v155, 0
  v_mov_b32 v156, 0
  v_mov_b32 v157, 0
  v_mov_b32 v158, 0
  v_mov_b32 v159, 0
  v_mov_b32 v160, 0
  v_mov_b32 v161, 0
  v_mov_b32 v162, 0
  v_mov_b32 v163, 0
  v_mov_b32 v164, 0
  v_mov_b32 v165, 0
  v_mov_b32 v166, 0
  v_mov_b32 v167, 0
  v_mov_b32 v168, 0
  v_mov_b32 v169, 0
  v_mov_b32 v170, 0
  v_mov_b32 v171, 0
  v_mov_b32 v172, 0
  v_mov_b32 v173, 0
  v_mov_b32 v174, 0
  v_mov_b32 v175, 0
  v_mov_b32 v176, 0
  v_mov_b32 v177, 0
  v_mov_b32 v178, 0
  v_mov_b32 v179, 0
  v_mov_b32 v180, 0
  v_mov_b32 v181, 0
  v_mov_b32 v182, 0
  v_mov_b32 v183, 0
  v_mov_b32 v184, 0
  v_mov_b32 v185, 0
  v_mov_b32 v186, 0
  v_mov_b32 v187, 0
  v_mov_b32 v188, 0
  v_mov_b32 v189, 0
  v_mov_b32 v190, 0
  v_mov_b32 v191, 0
  v_mov_b32 v192, 0
  v_mov_b32 v193, 0
  v_mov_b32 v194, 0
  v_mov_b32 v195, 0
  v_mov_b32 v196, 0
  v_mov_b32 v197, 0
  v_mov_b32 v198, 0
  v_mov_b32 v199, 0
  v_mov_b32 v200, 0
  v_mov_b32 v201, 0
  v_mov_b32 v202, 0
  v_mov_b32 v203, 0
  v_mov_b32 v204, 0
  v_mov_b32 v205, 0
  v_mov_b32 v206, 0
  v_mov_b32 v207, 0
  s_mov_b32 s24, s51
  s_mov_b32 s25, s51
  s_mov_b32 s30, 0x3db504f3
  s_mov_b32 s31, 0x3fb8aa3b
  s_mov_b32 s36, s30
  s_mov_b32 s37, s30
  s_mov_b32 s38, s31
  s_mov_b32 s39, s31
  v_mov_b32 v252, 0
  v_mov_b32 v253, 0
  v_mov_b32 v246, 0xf149f2ca
  s_add_u32 m0, s53, 0
  s_add_u32 s26, s24, 0
  buffer_load_dwordx4 v10, s[8:11], s26 offen lds
  s_add_u32 m0, s53, 4096
  s_add_u32 s26, s24, 131072
  buffer_load_dwordx4 v10, s[8:11], s26 offen lds
  s_add_u32 m0, s53, 8192
  s_add_u32 s26, s24, 262144
  buffer_load_dwordx4 v10, s[8:11], s26 offen lds
  s_add_u32 m0, s53, 12288
  s_add_u32 s26, s24, 393216
  buffer_load_dwordx4 v10, s[8:11], s26 offen lds
  s_add_u32 s24, s24, 524288
  s_add_u32 m0, s53, 16384
  s_add_u32 s26, s25, 0
  buffer_load_dwordx4 v11, s[12:15], s26 offen lds
  s_add_u32 m0, s53, 20480
  s_add_u32 s26, s25, 131072
  buffer_load_dwordx4 v11, s[12:15], s26 offen lds
  s_add_u32 m0, s53, 24576
  s_add_u32 s26, s25, 262144
  buffer_load_dwordx4 v11, s[12:15], s26 offen lds
  s_add_u32 m0, s53, 28672
  s_add_u32 s26, s25, 393216
  buffer_load_dwordx4 v11, s[12:15], s26 offen lds
  s_add_u32 s25, s25, 524288
  s_add_u32 m0, s53, 32768
  s_add_u32 s26, s24, 0
  buffer_load_dwordx4 v10, s[8:11], s26 offen lds
  s_add_u32 m0, s53, 36864
  s_add_u32 s26, s24, 131072
  buffer_load_dwordx4 v10, s[8:11], s26 offen lds
  s_add_u32 m0, s53, 40960
  s_add_u32 s26, s24, 262144
  buffer_load_dwordx4 v10, s[8:11], s26 offen lds
  s_add_u32 m0, s53, 45056
  s_add_u32 s26, s24, 393216
  buffer_load_dwordx4 v10, s[8:11], s26 offen lds
  s_add_u32 s24, s24, 524288
  s_waitcnt vmcnt(0)
  s_barrier
  ds_read_b128 v[208:211], v16 offset:0
  ds_read_b128 v[212:215], v17 offset:0
  ds_read_b128 v[216:219], v18 offset:0
  ds_read_b128 v[220:223], v19 offset:0
  ds_read_b128 v[224:227], v20 offset:0
  ds_read_b128 v[228:231], v21 offset:0
  ds_read_b128 v[232:235], v22 offset:0
  ds_read_b128 v[236:239], v23 offset:0
  s_waitcnt lgkmcnt(7)
  v_mfma_f32_32x32x16_bf16 v[64:79], v[208:211], v[32:35], 0
  ds_read_b128 v[208:211], v16 offset:8192
  s_waitcnt lgkmcnt(7)
  v_mfma_f32_32x32x16_bf16 v[64:79], v[212:215], v[36:39], v[64:79]
  ds_read_b128 v[212:215], v17 offset:8192
  s_waitcnt lgkmcnt(7)
  v_mfma_f32_32x32x16_bf16 v[64:79], v[216:219], v[40:43], v[64:79]
  ds_read_b128 v[216:219], v18 offset:8192
  s_waitcnt lgkmcnt(7)
  v_mfma_f32_32x32x16_bf16 v[64:79], v[220:223], v[44:47], v[64:79]
  ds_read_b128 v[220:223], v19 offset:8192
  s_waitcnt lgkmcnt(7)
  v_mfma_f32_32x32x16_bf16 v[64:79], v[224:227], v[48:51], v[64:79]
  ds_read_b128 v[224:227], v20 offset:8192
  s_waitcnt lgkmcnt(7)
  v_mfma_f32_32x32x16_bf16 v[64:79], v[228:231], v[52:55], v[64:79]
  ds_read_b128 v[228:231], v21 offset:8192
  s_waitcnt lgkmcnt(7)
  v_mfma_f32_32x32x16_bf16 v[64:79], v[232:235], v[56:59], v[64:79]
  ds_read_b128 v[232:235], v22 offset:8192
  s_waitcnt lgkmcnt(7)
  v_mfma_f32_32x32x16_bf16 v[64:79], v[236:239], v[60:63], v[64:79]
  ds_read_b128 v[236:239], v23 offset:8192
  s_waitcnt lgkmcnt(7)
  v_mfma_f32_32x32x16_bf16 v[80:95], v[208:211], v[32:35], 0
  s_waitcnt lgkmcnt(6)
  v_mfma_f32_32x32x16_bf16 v[80:95], v[212:215], v[36:39], v[80:95]
  s_waitcnt lgkmcnt(5)
  v_mfma_f32_32x32x16_bf16 v[80:95], v[216:219], v[40:43], v[80:95]
  s_waitcnt lgkmcnt(4)
  v_mfma_f32_32x32x16_bf16 v[80:95], v[220:223], v[44:47], v[80:95]
  s_waitcnt lgkmcnt(3)
  v_mfma_f32_32x32x16_bf16 v[80:95], v[224:227], v[48:51], v[80:95]
  s_waitcnt lgkmcnt(2)
  v_mfma_f32_32x32x16_bf16 v[80:95], v[228:231], v[52:55], v[80:95]
  s_waitcnt lgkmcnt(1)
  v_mfma_f32_32x32x16_bf16 v[80:95], v[232:235], v[56:59], v[80:95]
  s_waitcnt lgkmcnt(0)
  v_mfma_f32_32x32x16_bf16 v[80:95], v[236:239], v[60:63], v[80:95]
  s_nop 7
  s_nop 7
  v_cvt_pk_bf16_f32 v64, v64, v65
  v_and_b32 v65, 0xffff0000, v64
  v_lshlrev_b32 v64, 16, v64
  v_mul_f32 v64, s30, v64
  v_mul_f32 v65, s30, v65
  v_cvt_pk_bf16_f32 v64, v64, v65
  v_and_b32 v65, 0xffff0000, v64
  v_lshlrev_b32 v64, 16, v64
  v_cvt_pk_bf16_f32 v66, v66, v67
  v_and_b32 v67, 0xffff0000, v66
  v_lshlrev_b32 v66, 16, v66
  v_mul_f32 v66, s30, v66
  v_mul_f32 v67, s30, v67
  v_cvt_pk_bf16_f32 v66, v66, v67
  v_and_b32 v67, 0xffff0000, v66
  v_lshlrev_b32 v66, 16, v66
  v_cvt_pk_bf16_f32 v68, v68, v69
  v_and_b32 v69, 0xffff0000, v68
  v_lshlrev_b32 v68, 16, v68
  v_mul_f32 v68, s30, v68
  v_mul_f32 v69, s30, v69
  v_cvt_pk_bf16_f32 v68, v68, v69
  v_and_b32 v69, 0xffff0000, v68
  v_lshlrev_b32 v68, 16, v68
  v_cvt_pk_bf16_f32 v70, v70, v71
  v_and_b32 v71, 0xffff0000, v70
  v_lshlrev_b32 v70, 16, v70
  v_mul_f32 v70, s30, v70
  v_mul_f32 v71, s30, v71
  v_cvt_pk_bf16_f32 v70, v70, v71
  v_and_b32 v71, 0xffff0000, v70
  v_lshlrev_b32 v70, 16, v70
  v_cvt_pk_bf16_f32 v72, v72, v73
  v_and_b32 v73, 0xffff0000, v72
  v_lshlrev_b32 v72, 16, v72
  v_mul_f32 v72, s30, v72
  v_mul_f32 v73, s30, v73
  v_cvt_pk_bf16_f32 v72, v72, v73
  v_and_b32 v73, 0xffff0000, v72
  v_lshlrev_b32 v72, 16, v72
  v_cvt_pk_bf16_f32 v74, v74, v75
  v_and_b32 v75, 0xffff0000, v74
  v_lshlrev_b32 v74, 16, v74
  v_mul_f32 v74, s30, v74
  v_mul_f32 v75, s30, v75
  v_cvt_pk_bf16_f32 v74, v74, v75
  v_and_b32 v75, 0xffff0000, v74
  v_lshlrev_b32 v74, 16, v74
  v_cvt_pk_bf16_f32 v76, v76, v77
  v_and_b32 v77, 0xffff0000, v76
  v_lshlrev_b32 v76, 16, v76
  v_mul_f32 v76, s30, v76
  v_mul_f32 v77, s30, v77
  v_cvt_pk_bf16_f32 v76, v76, v77
  v_and_b32 v77, 0xffff0000, v76
  v_lshlrev_b32 v76, 16, v76
  v_cvt_pk_bf16_f32 v78, v78, v79
  v_and_b32 v79, 0xffff0000, v78
  v_lshlrev_b32 v78, 16, v78
  v_mul_f32 v78, s30, v78
  v_mul_f32 v79, s30, v79
  v_cvt_pk_bf16_f32 v78, v78, v79
  v_and_b32 v79, 0xffff0000, v78
  v_lshlrev_b32 v78, 16, v78
  v_cvt_pk_bf16_f32 v80, v80, v81
  v_and_b32 v81, 0xffff0000, v80
  v_lshlrev_b32 v80, 16, v80
  v_mul_f32 v80, s30, v80
  v_mul_f32 v81, s30, v81
  v_cvt_pk_bf16_f32 v80, v80, v81
  v_and_b32 v81, 0xffff0000, v80
  v_lshlrev_b32 v80, 16, v80
  v_cvt_pk_bf16_f32 v82, v82, v83
  v_and_b32 v83, 0xffff0000, v82
  v_lshlrev_b32 v82, 16, v82
  v_mul_f32 v82, s30, v82
  v_mul_f32 v83, s30, v83
  v_cvt_pk_bf16_f32 v82, v82, v83
  v_and_b32 v83, 0xffff0000, v82
  v_lshlrev_b32 v82, 16, v82
  v_cvt_pk_bf16_f32 v84, v84, v85
  v_and_b32 v85, 0xffff0000, v84
  v_lshlrev_b32 v84, 16, v84
  v_mul_f32 v84, s30, v84
  v_mul_f32 v85, s30, v85
  v_cvt_pk_bf16_f32 v84, v84, v85
  v_and_b32 v85, 0xffff0000, v84
  v_lshlrev_b32 v84, 16, v84
  v_cvt_pk_bf16_f32 v86, v86, v87
  v_and_b32 v87, 0xffff0000, v86
  v_lshlrev_b32 v86, 16, v86
  v_mul_f32 v86, s30, v86
  v_mul_f32 v87, s30, v87
  v_cvt_pk_bf16_f32 v86, v86, v87
  v_and_b32 v87, 0xffff0000, v86
  v_lshlrev_b32 v86, 16, v86
  v_cvt_pk_bf16_f32 v88, v88, v89
  v_and_b32 v89, 0xffff0000, v88
  v_lshlrev_b32 v88, 16, v88
  v_mul_f32 v88, s30, v88
  v_mul_f32 v89, s30, v89
  v_cvt_pk_bf16_f32 v88, v88, v89
  v_and_b32 v89, 0xffff0000, v88
  v_lshlrev_b32 v88, 16, v88
  v_cvt_pk_bf16_f32 v90, v90, v91
  v_and_b32 v91, 0xffff0000, v90
  v_lshlrev_b32 v90, 16, v90
  v_mul_f32 v90, s30, v90
  v_mul_f32 v91, s30, v91
  v_cvt_pk_bf16_f32 v90, v90, v91
  v_and_b32 v91, 0xffff0000, v90
  v_lshlrev_b32 v90, 16, v90
  v_cvt_pk_bf16_f32 v92, v92, v93
  v_and_b32 v93, 0xffff0000, v92
  v_lshlrev_b32 v92, 16, v92
  v_mul_f32 v92, s30, v92
  v_mul_f32 v93, s30, v93
  v_cvt_pk_bf16_f32 v92, v92, v93
  v_and_b32 v93, 0xffff0000, v92
  v_lshlrev_b32 v92, 16, v92
  v_cvt_pk_bf16_f32 v94, v94, v95
  v_and_b32 v95, 0xffff0000, v94
  v_lshlrev_b32 v94, 16, v94
  v_mul_f32 v94, s30, v94
  v_mul_f32 v95, s30, v95
  v_cvt_pk_bf16_f32 v94, v94, v95
  v_and_b32 v95, 0xffff0000, v94
  v_lshlrev_b32 v94, 16, v94
  s_mov_b32 s21, 0
  s_add_u32 s26, s21, 63
  s_cmp_le_u32 s26, s18
  s_cbranch_scc1 L_attn_kernel_nm_p
  v_lshlrev_b32 v244, 2, v4
  v_add_u32 v244, s21, v244

  v_add_u32 v245, 0, v244
  v_cmp_gt_u32 vcc, v245, v5
  v_cndmask_b32 v64, v64, v246, vcc
  v_add_u32 v245, 1, v244
  v_cmp_gt_u32 vcc, v245, v5
  v_cndmask_b32 v65, v65, v246, vcc
  v_add_u32 v245, 2, v244
  v_cmp_gt_u32 vcc, v245, v5
  v_cndmask_b32 v66, v66, v246, vcc
  v_add_u32 v245, 3, v244
  v_cmp_gt_u32 vcc, v245, v5
  v_cndmask_b32 v67, v67, v246, vcc
  v_add_u32 v245, 8, v244
  v_cmp_gt_u32 vcc, v245, v5
  v_cndmask_b32 v68, v68, v246, vcc
  v_add_u32 v245, 9, v244
  v_cmp_gt_u32 vcc, v245, v5
  v_cndmask_b32 v69, v69, v246, vcc
  v_add_u32 v245, 10, v244
  v_cmp_gt_u32 vcc, v245, v5
  v_cndmask_b32 v70, v70, v246, vcc
  v_add_u32 v245, 11, v244
  v_cmp_gt_u32 vcc, v245, v5
  v_cndmask_b32 v71, v71, v246, vcc
  v_add_u32 v245, 16, v244
  v_cmp_gt_u32 vcc, v245, v5
  v_cndmask_b32 v72, v72, v246, vcc
  v_add_u32 v245, 17, v244
  v_cmp_gt_u32 vcc, v245, v5
  v_cndmask_b32 v73, v73, v246, vcc
  v_add_u32 v245, 18, v244
  v_cmp_gt_u32 vcc, v245, v5
  v_cndmask_b32 v74, v74, v246, vcc
  v_add_u32 v245, 19, v244
  v_cmp_gt_u32 vcc, v245, v5
  v_cndmask_b32 v75, v75, v246, vcc
  v_add_u32 v245, 24, v244
  v_cmp_gt_u32 vcc, v245, v5
  v_cndmask_b32 v76, v76, v246, vcc
  v_add_u32 v245, 25, v244
  v_cmp_gt_u32 vcc, v245, v5
  v_cndmask_b32 v77, v77, v246, vcc
  v_add_u32 v245, 26, v244
  v_cmp_gt_u32 vcc, v245, v5
  v_cndmask_b32 v78, v78, v246, vcc
  v_add_u32 v245, 27, v244
  v_cmp_gt_u32 vcc, v245, v5
  v_cndmask_b32 v79, v79, v246, vcc
  v_add_u32 v245, 32, v244
  v_cmp_gt_u32 vcc, v245, v5
  v_cndmask_b32 v80, v80, v246, vcc
  v_add_u32 v245, 33, v244
  v_cmp_gt_u32 vcc, v245, v5
  v_cndmask_b32 v81, v81, v246, vcc
  v_add_u32 v245, 34, v244
  v_cmp_gt_u32 vcc, v245, v5
  v_cndmask_b32 v82, v82, v246, vcc
  v_add_u32 v245, 35, v244
  v_cmp_gt_u32 vcc, v245, v5
  v_cndmask_b32 v83, v83, v246, vcc
  v_add_u32 v245, 40, v244
  v_cmp_gt_u32 vcc, v245, v5
  v_cndmask_b32 v84, v84, v246, vcc
  v_add_u32 v245, 41, v244
  v_cmp_gt_u32 vcc, v245, v5
  v_cndmask_b32 v85, v85, v246, vcc
  v_add_u32 v245, 42, v244
  v_cmp_gt_u32 vcc, v245, v5
  v_cndmask_b32 v86, v86, v246, vcc
  v_add_u32 v245, 43, v244
  v_cmp_gt_u32 vcc, v245, v5
  v_cndmask_b32 v87, v87, v246, vcc
  v_add_u32 v245, 48, v244
  v_cmp_gt_u32 vcc, v245, v5
  v_cndmask_b32 v88, v88, v246, vcc
  v_add_u32 v245, 49, v244
  v_cmp_gt_u32 vcc, v245, v5
  v_cndmask_b32 v89, v89, v246, vcc
  v_add_u32 v245, 50, v244
  v_cmp_gt_u32 vcc, v245, v5
  v_cndmask_b32 v90, v90, v246, vcc
  v_add_u32 v245, 51, v244
  v_cmp_gt_u32 vcc, v245, v5
  v_cndmask_b32 v91, v91, v246, vcc
  v_add_u32 v245, 56, v244
  v_cmp_gt_u32 vcc, v245, v5
  v_cndmask_b32 v92, v92, v246, vcc
  v_add_u32 v245, 57, v244
  v_cmp_gt_u32 vcc, v245, v5
  v_cndmask_b32 v93, v93, v246, vcc
  v_add_u32 v245, 58, v244
  v_cmp_gt_u32 vcc, v245, v5
  v_cndmask_b32 v94, v94, v246, vcc
  v_add_u32 v245, 59, v244
  v_cmp_gt_u32 vcc, v245, v5
  v_cndmask_b32 v95, v95, v246, vcc
L_attn_kernel_nm_p:
  s_mov_b32 s22, s19
  s_barrier
L_attn_kernel_loop:
  s_add_u32 m0, s53, 0
  s_add_u32 s26, s24, 0
  buffer_load_dwordx4 v10, s[8:11], s26 offen lds
  s_add_u32 m0, s53, 4096
  s_add_u32 s26, s24, 131072
  buffer_load_dwordx4 v10, s[8:11], s26 offen lds
  s_add_u32 m0, s53, 8192
  s_add_u32 s26, s24, 262144
  buffer_load_dwordx4 v10, s[8:11], s26 offen lds
  s_add_u32 m0, s53, 12288
  s_add_u32 s26, s24, 393216
  buffer_load_dwordx4 v10, s[8:11], s26 offen lds
  s_add_u32 s24, s24, 524288
  s_add_u32 m0, s53, 49152
  s_add_u32 s26, s25, 0
  buffer_load_dwordx4 v11, s[12:15], s26 offen lds
  s_add_u32 m0, s53, 53248
  s_add_u32 s26, s25, 131072
  buffer_load_dwordx4 v11, s[12:15], s26 offen lds
  s_add_u32 m0, s53, 57344
  s_add_u32 s26, s25, 262144
  buffer_load_dwordx4 v11, s[12:15], s26 offen lds
  s_add_u32 m0, s53, 61440
  s_add_u32 s26, s25, 393216
  buffer_load_dwordx4 v11, s[12:15], s26 offen lds
  s_add_u32 s25, s25, 524288
  v_max3_f32 v243, v64, v65, v66
  v_max3_f32 v243, v243, v67, v68
  v_max3_f32 v243, v243, v69, v70
  v_max3_f32 v243, v243, v71, v72
  v_max3_f32 v243, v243, v73, v74
  v_max3_f32 v243, v243, v75, v76
  v_max3_f32 v243, v243, v77, v78
  v_max3_f32 v243, v243, v79, v80
  v_max3_f32 v243, v243, v81, v82
  v_max3_f32 v243, v243, v83, v84
  v_max3_f32 v243, v243, v85, v86
  v_max3_f32 v243, v243, v87, v88
  v_max3_f32 v243, v243, v89, v90
  v_max3_f32 v243, v243, v91, v92
  v_max3_f32 v243, v243, v93, v94
  v_max_f32 v243, v243, v95
  v_mov_b32 v244, v243
  s_nop 1
  v_permlane32_swap_b32 v244, v243
  s_nop 1
  ds_read_b128 v[208:211], v16 offset:32768
  ds_read_b128 v[212:215], v17 offset:32768
  ds_read_b128 v[216:219], v18 offset:32768
  ds_read_b128 v[220:223], v19 offset:32768
  ds_read_b128 v[224:227], v20 offset:32768
  ds_read_b128 v[228:231], v21 offset:32768
  ds_read_b128 v[232:235], v22 offset:32768
  ds_read_b128 v[236:239], v23 offset:32768
  s_waitcnt lgkmcnt(7)
  v_mfma_f32_32x32x16_bf16 v[96:111], v[208:211], v[32:35], 0
  v_max3_f32 v243, v243, v244, v240
  v_sub_f32 v244, v240, v243
  v_mul_f32 v244, s31, v244
  v_exp_f32 v244, v244
  v_mov_b32 v240, v243
  v_mul_f32 v245, s31, v243
  v_fma_f32 v64, v64, s31, -v245
  v_exp_f32 v64, v64
  v_fma_f32 v65, v65, s31, -v245
  v_exp_f32 v65, v65
  v_fma_f32 v66, v66, s31, -v245
  ds_read_b128 v[208:211], v16 offset:40960
  s_waitcnt lgkmcnt(7)
  v_mfma_f32_32x32x16_bf16 v[96:111], v[212:215], v[36:39], v[96:111]
  v_exp_f32 v66, v66
  v_fma_f32 v67, v67, s31, -v245
  v_exp_f32 v67, v67
  v_fma_f32 v68, v68, s31, -v245
  v_exp_f32 v68, v68
  v_fma_f32 v69, v69, s31, -v245
  v_exp_f32 v69, v69
  v_fma_f32 v70, v70, s31, -v245
  v_exp_f32 v70, v70
  v_fma_f32 v71, v71, s31, -v245
  v_exp_f32 v71, v71
  ds_read_b128 v[212:215], v17 offset:40960
  s_waitcnt lgkmcnt(7)
  v_mfma_f32_32x32x16_bf16 v[96:111], v[216:219], v[40:43], v[96:111]
  v_fma_f32 v72, v72, s31, -v245
  v_exp_f32 v72, v72
  v_fma_f32 v73, v73, s31, -v245
  v_exp_f32 v73, v73
  v_fma_f32 v74, v74, s31, -v245
  v_exp_f32 v74, v74
  v_fma_f32 v75, v75, s31, -v245
  v_exp_f32 v75, v75
  v_fma_f32 v76, v76, s31, -v245
  v_exp_f32 v76, v76
  v_fma_f32 v77, v77, s31, -v245
  v_exp_f32 v77, v77
  ds_read_b128 v[216:219], v18 offset:40960
  s_waitcnt lgkmcnt(7)
  v_mfma_f32_32x32x16_bf16 v[96:111], v[220:223], v[44:47], v[96:111]
  v_fma_f32 v78, v78, s31, -v245
  v_exp_f32 v78, v78
  v_fma_f32 v79, v79, s31, -v245
  v_exp_f32 v79, v79
  v_fma_f32 v80, v80, s31, -v245
  v_exp_f32 v80, v80
  v_fma_f32 v81, v81, s31, -v245
  v_exp_f32 v81, v81
  v_fma_f32 v82, v82, s31, -v245
  v_exp_f32 v82, v82
  v_fma_f32 v83, v83, s31, -v245
  ds_read_b128 v[220:223], v19 offset:40960
  s_waitcnt lgkmcnt(7)
  v_mfma_f32_32x32x16_bf16 v[96:111], v[224:227], v[48:51], v[96:111]
  v_exp_f32 v83, v83
  v_fma_f32 v84, v84, s31, -v245
  v_exp_f32 v84, v84
  v_fma_f32 v85, v85, s31, -v245
  v_exp_f32 v85, v85
  v_fma_f32 v86, v86, s31, -v245
  v_exp_f32 v86, v86
  v_fma_f32 v87, v87, s31, -v245
  v_exp_f32 v87, v87
  v_fma_f32 v88, v88, s31, -v245
  v_exp_f32 v88, v88
  v_fma_f32 v89, v89, s31, -v245
  ds_read_b128 v[224:227], v20 offset:40960
  s_waitcnt lgkmcnt(7)
  v_mfma_f32_32x32x16_bf16 v[96:111], v[228:231], v[52:55], v[96:111]
  v_exp_f32 v89, v89
  v_fma_f32 v90, v90, s31, -v245
  v_exp_f32 v90, v90
  v_fma_f32 v91, v91, s31, -v245
  v_exp_f32 v91, v91
  v_fma_f32 v92, v92, s31, -v245
  v_exp_f32 v92, v92
  v_fma_f32 v93, v93, s31, -v245
  v_exp_f32 v93, v93
  v_fma_f32 v94, v94, s31, -v245
  v_exp_f32 v94, v94
  ds_read_b128 v[228:231], v21 offset:40960
  s_waitcnt lgkmcnt(7)
  v_mfma_f32_32x32x16_bf16 v[96:111], v[232:235], v[56:59], v[96:111]
  v_fma_f32 v95, v95, s31, -v245
  v_exp_f32 v95, v95
  v_mul_f32 v241, v241, v244
  v_add_f32 v241, v241, v64
  v_add_f32 v241, v241, v65
  v_cvt_pk_bf16_f32 v128, v64, v65
  v_add_f32 v241, v241, v66
  v_add_f32 v241, v241, v67
  v_cvt_pk_bf16_f32 v129, v66, v67
  v_add_f32 v241, v241, v68
  v_add_f32 v241, v241, v69
  v_cvt_pk_bf16_f32 v130, v68, v69
  ds_read_b128 v[232:235], v22 offset:40960
  s_waitcnt lgkmcnt(7)
  v_mfma_f32_32x32x16_bf16 v[96:111], v[236:239], v[60:63], v[96:111]
  v_add_f32 v241, v241, v70
  v_add_f32 v241, v241, v71
  v_cvt_pk_bf16_f32 v131, v70, v71
  v_add_f32 v241, v241, v72
  v_add_f32 v241, v241, v73
  v_cvt_pk_bf16_f32 v132, v72, v73
  v_add_f32 v241, v241, v74
  v_add_f32 v241, v241, v75
  v_cvt_pk_bf16_f32 v133, v74, v75
  v_add_f32 v241, v241, v76
  v_add_f32 v241, v241, v77
  ds_read_b128 v[236:239], v23 offset:40960
  s_waitcnt lgkmcnt(7)
  v_mfma_f32_32x32x16_bf16 v[112:127], v[208:211], v[32:35], 0
  v_cvt_pk_bf16_f32 v134, v76, v77
  v_add_f32 v241, v241, v78
  v_add_f32 v241, v241, v79
  v_cvt_pk_bf16_f32 v135, v78, v79
  v_add_f32 v241, v241, v80
  v_add_f32 v241, v241, v81
  v_cvt_pk_bf16_f32 v136, v80, v81
  v_add_f32 v241, v241, v82
  v_add_f32 v241, v241, v83
  v_cvt_pk_bf16_f32 v137, v82, v83
  v_add_f32 v241, v241, v84
  s_waitcnt lgkmcnt(6)
  v_mfma_f32_32x32x16_bf16 v[112:127], v[212:215], v[36:39], v[112:127]
  v_add_f32 v241, v241, v85
  v_cvt_pk_bf16_f32 v138, v84, v85
  v_add_f32 v241, v241, v86
  v_add_f32 v241, v241, v87
  v_cvt_pk_bf16_f32 v139, v86, v87
  v_add_f32 v241, v241, v88
  v_add_f32 v241, v241, v89
  v_cvt_pk_bf16_f32 v140, v88, v89
  v_add_f32 v241, v241, v90
  v_add_f32 v241, v241, v91
  v_cvt_pk_bf16_f32 v141, v90, v91
  v_add_f32 v241, v241, v92
  s_waitcnt lgkmcnt(5)
  v_mfma_f32_32x32x16_bf16 v[112:127], v[216:219], v[40:43], v[112:127]
  v_add_f32 v241, v241, v93
  v_cvt_pk_bf16_f32 v142, v92, v93
  v_add_f32 v241, v241, v94
  v_add_f32 v241, v241, v95
  v_cvt_pk_bf16_f32 v143, v94, v95
  v_mul_f32 v144, v144, v244
  v_mul_f32 v145, v145, v244
  v_mul_f32 v146, v146, v244
  v_mul_f32 v147, v147, v244
  v_mul_f32 v148, v148, v244
  v_mul_f32 v149, v149, v244
  s_waitcnt lgkmcnt(4)
  v_mfma_f32_32x32x16_bf16 v[112:127], v[220:223], v[44:47], v[112:127]
  v_mul_f32 v150, v150, v244
  v_mul_f32 v151, v151, v244
  v_mul_f32 v152, v152, v244
  v_mul_f32 v153, v153, v244
  v_mul_f32 v154, v154, v244
  v_mul_f32 v155, v155, v244
  v_mul_f32 v156, v156, v244
  v_mul_f32 v157, v157, v244
  v_mul_f32 v158, v158, v244
  v_mul_f32 v159, v159, v244
  v_mul_f32 v160, v160, v244
  v_mul_f32 v161, v161, v244
  s_waitcnt lgkmcnt(3)
  v_mfma_f32_32x32x16_bf16 v[112:127], v[224:227], v[48:51], v[112:127]
  v_mul_f32 v162, v162, v244
  v_mul_f32 v163, v163, v244
  v_mul_f32 v164, v164, v244
  v_mul_f32 v165, v165, v244
  v_mul_f32 v166, v166, v244
  v_mul_f32 v167, v167, v244
  v_mul_f32 v168, v168, v244
  v_mul_f32 v169, v169, v244
  v_mul_f32 v170, v170, v244
  v_mul_f32 v171, v171, v244
  v_mul_f32 v172, v172, v244
  s_waitcnt lgkmcnt(2)
  v_mfma_f32_32x32x16_bf16 v[112:127], v[228:231], v[52:55], v[112:127]
  v_mul_f32 v173, v173, v244
  v_mul_f32 v174, v174, v244
  v_mul_f32 v175, v175, v244
  v_mul_f32 v176, v176, v244
  v_mul_f32 v177, v177, v244
  v_mul_f32 v178, v178, v244
  v_mul_f32 v179, v179, v244
  v_mul_f32 v180, v180, v244
  v_mul_f32 v181, v181, v244
  v_mul_f32 v182, v182, v244
  v_mul_f32 v183, v183, v244
  v_mul_f32 v184, v184, v244
  s_waitcnt lgkmcnt(1)
  v_mfma_f32_32x32x16_bf16 v[112:127], v[232:235], v[56:59], v[112:127]
  v_mul_f32 v185, v185, v244
  v_mul_f32 v186, v186, v244
  v_mul_f32 v187, v187, v244
  v_mul_f32 v188, v188, v244
  v_mul_f32 v189, v189, v244
  v_mul_f32 v190, v190, v244
  v_mul_f32 v191, v191, v244
  v_mul_f32 v192, v192, v244
  v_mul_f32 v193, v193, v244
  v_mul_f32 v194, v194, v244
  v_mul_f32 v195, v195, v244
  s_waitcnt lgkmcnt(0)
  v_mfma_f32_32x32x16_bf16 v[112:127], v[236:239], v[60:63], v[112:127]
  v_mul_f32 v196, v196, v244
  v_mul_f32 v197, v197, v244
  v_mul_f32 v198, v198, v244
  v_mul_f32 v199, v199, v244
  v_mul_f32 v200, v200, v244
  v_mul_f32 v201, v201, v244
  v_mul_f32 v202, v202, v244
  v_mul_f32 v203, v203, v244
  v_mul_f32 v204, v204, v244
  v_mul_f32 v205, v205, v244
  v_mul_f32 v206, v206, v244
  v_mul_f32 v207, v207, v244
  s_nop 1
  ds_read_b64_tr_b16 v[208:209], v24 offset:0
  ds_read_b64_tr_b16 v[210:211], v24 offset:2048
  ds_read_b64_tr_b16 v[212:213], v24 offset:4096
  ds_read_b64_tr_b16 v[214:215], v24 offset:6144
  ds_read_b64_tr_b16 v[216:217], v24 offset:8192
  ds_read_b64_tr_b16 v[218:219], v24 offset:10240
  ds_read_b64_tr_b16 v[220:221], v24 offset:12288
  ds_read_b64_tr_b16 v[222:223], v24 offset:14336
  ds_read_b64_tr_b16 v[224:225], v25 offset:0
  ds_read_b64_tr_b16 v[226:227], v25 offset:2048
  ds_read_b64_tr_b16 v[228:229], v25 offset:4096
  ds_read_b64_tr_b16 v[230:231], v25 offset:6144
  ds_read_b64_tr_b16 v[232:233], v25 offset:8192
  ds_read_b64_tr_b16 v[234:235], v25 offset:10240
  ds_read_b64_tr_b16 v[236:237], v25 offset:12288
  ds_read_b64_tr_b16 v[238:239], v25 offset:14336
  s_waitcnt lgkmcnt(14)
  v_mfma_f32_32x32x16_bf16 v[144:159], v[208:211], v[128:131], v[144:159]
  v_cvt_pk_bf16_f32 v96, v96, v97
  v_and_b32 v97, 0xffff0000, v96
  v_lshlrev_b32 v96, 16, v96
  v_mul_f32 v96, s30, v96
  v_mul_f32 v97, s30, v97
  v_cvt_pk_bf16_f32 v96, v96, v97
  v_and_b32 v97, 0xffff0000, v96
  v_lshlrev_b32 v96, 16, v96
  ds_read_b64_tr_b16 v[208:209], v26 offset:0
  ds_read_b64_tr_b16 v[210:211], v26 offset:2048
  s_waitcnt lgkmcnt(14)
  v_mfma_f32_32x32x16_bf16 v[144:159], v[212:215], v[132:135], v[144:159]
  v_cvt_pk_bf16_f32 v98, v98, v99
  v_and_b32 v99, 0xffff0000, v98
  v_lshlrev_b32 v98, 16, v98
  v_mul_f32 v98, s30, v98
  v_mul_f32 v99, s30, v99
  v_cvt_pk_bf16_f32 v98, v98, v99
  v_and_b32 v99, 0xffff0000, v98
  v_lshlrev_b32 v98, 16, v98
  ds_read_b64_tr_b16 v[212:213], v26 offset:4096
  ds_read_b64_tr_b16 v[214:215], v26 offset:6144
  s_waitcnt lgkmcnt(14)
  v_mfma_f32_32x32x16_bf16 v[144:159], v[216:219], v[136:139], v[144:159]
  v_cvt_pk_bf16_f32 v100, v100, v101
  v_and_b32 v101, 0xffff0000, v100
  v_lshlrev_b32 v100, 16, v100
  v_mul_f32 v100, s30, v100
  v_mul_f32 v101, s30, v101
  v_cvt_pk_bf16_f32 v100, v100, v101
  v_and_b32 v101, 0xffff0000, v100
  v_lshlrev_b32 v100, 16, v100
  ds_read_b64_tr_b16 v[216:217], v26 offset:8192
  ds_read_b64_tr_b16 v[218:219], v26 offset:10240
  s_waitcnt lgkmcnt(14)
  v_mfma_f32_32x32x16_bf16 v[144:159], v[220:223], v[140:143], v[144:159]
  v_cvt_pk_bf16_f32 v102, v102, v103
  v_and_b32 v103, 0xffff0000, v102
  v_lshlrev_b32 v102, 16, v102
  v_mul_f32 v102, s30, v102
  v_mul_f32 v103, s30, v103
  v_cvt_pk_bf16_f32 v102, v102, v103
  v_and_b32 v103, 0xffff0000, v102
  v_lshlrev_b32 v102, 16, v102
  ds_read_b64_tr_b16 v[220:221], v26 offset:12288
  ds_read_b64_tr_b16 v[222:223], v26 offset:14336
  s_waitcnt lgkmcnt(14)
  v_mfma_f32_32x32x16_bf16 v[160:175], v[224:227], v[128:131], v[160:175]
  v_cvt_pk_bf16_f32 v104, v104, v105
  v_and_b32 v105, 0xffff0000, v104
  v_lshlrev_b32 v104, 16, v104
  v_mul_f32 v104, s30, v104
  v_mul_f32 v105, s30, v105
  v_cvt_pk_bf16_f32 v104, v104, v105
  v_and_b32 v105, 0xffff0000, v104
  v_lshlrev_b32 v104, 16, v104
  ds_read_b64_tr_b16 v[224:225], v27 offset:0
  ds_read_b64_tr_b16 v[226:227], v27 offset:2048
  s_waitcnt lgkmcnt(14)
  v_mfma_f32_32x32x16_bf16 v[160:175], v[228:231], v[132:135], v[160:175]
  v_cvt_pk_bf16_f32 v106, v106, v107
  v_and_b32 v107, 0xffff0000, v106
  v_lshlrev_b32 v106, 16, v106
  v_mul_f32 v106, s30, v106
  v_mul_f32 v107, s30, v107
  v_cvt_pk_bf16_f32 v106, v106, v107
  v_and_b32 v107, 0xffff0000, v106
  v_lshlrev_b32 v106, 16, v106
  ds_read_b64_tr_b16 v[228:229], v27 offset:4096
  ds_read_b64_tr_b16 v[230:231], v27 offset:6144
  s_waitcnt lgkmcnt(14)
  v_mfma_f32_32x32x16_bf16 v[160:175], v[232:235], v[136:139], v[160:175]
  v_cvt_pk_bf16_f32 v108, v108, v109
  v_and_b32 v109, 0xffff0000, v108
  v_lshlrev_b32 v108, 16, v108
  v_mul_f32 v108, s30, v108
  v_mul_f32 v109, s30, v109
  v_cvt_pk_bf16_f32 v108, v108, v109
  v_and_b32 v109, 0xffff0000, v108
  v_lshlrev_b32 v108, 16, v108
  ds_read_b64_tr_b16 v[232:233], v27 offset:8192
  ds_read_b64_tr_b16 v[234:235], v27 offset:10240
  s_waitcnt lgkmcnt(14)
  v_mfma_f32_32x32x16_bf16 v[160:175], v[236:239], v[140:143], v[160:175]
  v_cvt_pk_bf16_f32 v110, v110, v111
  v_and_b32 v111, 0xffff0000, v110
  v_lshlrev_b32 v110, 16, v110
  v_mul_f32 v110, s30, v110
  v_mul_f32 v111, s30, v111
  v_cvt_pk_bf16_f32 v110, v110, v111
  v_and_b32 v111, 0xffff0000, v110
  v_lshlrev_b32 v110, 16, v110
  ds_read_b64_tr_b16 v[236:237], v27 offset:12288
  ds_read_b64_tr_b16 v[238:239], v27 offset:14336
  s_waitcnt lgkmcnt(14)
  v_mfma_f32_32x32x16_bf16 v[176:191], v[208:211], v[128:131], v[176:191]
  v_cvt_pk_bf16_f32 v112, v112, v113
  v_and_b32 v113, 0xffff0000, v112
  v_lshlrev_b32 v112, 16, v112
  v_mul_f32 v112, s30, v112
  v_mul_f32 v113, s30, v113
  v_cvt_pk_bf16_f32 v112, v112, v113
  v_and_b32 v113, 0xffff0000, v112
  v_lshlrev_b32 v112, 16, v112
  s_waitcnt lgkmcnt(12)
  v_mfma_f32_32x32x16_bf16 v[176:191], v[212:215], v[132:135], v[176:191]
  v_cvt_pk_bf16_f32 v114, v114, v115
  v_and_b32 v115, 0xffff0000, v114
  v_lshlrev_b32 v114, 16, v114
  v_mul_f32 v114, s30, v114
  v_mul_f32 v115, s30, v115
  v_cvt_pk_bf16_f32 v114, v114, v115
  v_and_b32 v115, 0xffff0000, v114
  v_lshlrev_b32 v114, 16, v114
  s_waitcnt lgkmcnt(10)
  v_mfma_f32_32x32x16_bf16 v[176:191], v[216:219], v[136:139], v[176:191]
  v_cvt_pk_bf16_f32 v116, v116, v117
  v_and_b32 v117, 0xffff0000, v116
  v_lshlrev_b32 v116, 16, v116
  v_mul_f32 v116, s30, v116
  v_mul_f32 v117, s30, v117
  v_cvt_pk_bf16_f32 v116, v116, v117
  v_and_b32 v117, 0xffff0000, v116
  v_lshlrev_b32 v116, 16, v116
  s_waitcnt lgkmcnt(8)
  v_mfma_f32_32x32x16_bf16 v[176:191], v[220:223], v[140:143], v[176:191]
  v_cvt_pk_bf16_f32 v118, v118, v119
  v_and_b32 v119, 0xffff0000, v118
  v_lshlrev_b32 v118, 16, v118
  v_mul_f32 v118, s30, v118
  v_mul_f32 v119, s30, v119
  v_cvt_pk_bf16_f32 v118, v118, v119
  v_and_b32 v119, 0xffff0000, v118
  v_lshlrev_b32 v118, 16, v118
  s_waitcnt lgkmcnt(6)
  v_mfma_f32_32x32x16_bf16 v[192:207], v[224:227], v[128:131], v[192:207]
  v_cvt_pk_bf16_f32 v120, v120, v121
  v_and_b32 v121, 0xffff0000, v120
  v_lshlrev_b32 v120, 16, v120
  v_mul_f32 v120, s30, v120
  v_mul_f32 v121, s30, v121
  v_cvt_pk_bf16_f32 v120, v120, v121
  v_and_b32 v121, 0xffff0000, v120
  v_lshlrev_b32 v120, 16, v120
  s_waitcnt lgkmcnt(4)
  v_mfma_f32_32x32x16_bf16 v[192:207], v[228:231], v[132:135], v[192:207]
  v_cvt_pk_bf16_f32 v122, v122, v123
  v_and_b32 v123, 0xffff0000, v122
  v_lshlrev_b32 v122, 16, v122
  v_mul_f32 v122, s30, v122
  v_mul_f32 v123, s30, v123
  v_cvt_pk_bf16_f32 v122, v122, v123
  v_and_b32 v123, 0xffff0000, v122
  v_lshlrev_b32 v122, 16, v122
  s_waitcnt lgkmcnt(2)
  v_mfma_f32_32x32x16_bf16 v[192:207], v[232:235], v[136:139], v[192:207]
  v_cvt_pk_bf16_f32 v124, v124, v125
  v_and_b32 v125, 0xffff0000, v124
  v_lshlrev_b32 v124, 16, v124
  v_mul_f32 v124, s30, v124
  v_mul_f32 v125, s30, v125
  v_cvt_pk_bf16_f32 v124, v124, v125
  v_and_b32 v125, 0xffff0000, v124
  v_lshlrev_b32 v124, 16, v124
  s_waitcnt lgkmcnt(0)
  v_mfma_f32_32x32x16_bf16 v[192:207], v[236:239], v[140:143], v[192:207]
  v_cvt_pk_bf16_f32 v126, v126, v127
  v_and_b32 v127, 0xffff0000, v126
  v_lshlrev_b32 v126, 16, v126
  v_mul_f32 v126, s30, v126
  v_mul_f32 v127, s30, v127
  v_cvt_pk_bf16_f32 v126, v126, v127
  v_and_b32 v127, 0xffff0000, v126
  v_lshlrev_b32 v126, 16, v126
  s_add_u32 s21, s21, 64
  s_add_u32 s26, s21, 63
  s_cmp_le_u32 s26, s18
  s_cbranch_scc1 L_attn_kernel_nm0
  v_lshlrev_b32 v244, 2, v4
  v_add_u32 v244, s21, v244

  v_add_u32 v245, 0, v244
  v_cmp_gt_u32 vcc, v245, v5
  v_cndmask_b32 v96, v96, v246, vcc
  v_add_u32 v245, 1, v244
  v_cmp_gt_u32 vcc, v245, v5
  v_cndmask_b32 v97, v97, v246, vcc
  v_add_u32 v245, 2, v244
  v_cmp_gt_u32 vcc, v245, v5
  v_cndmask_b32 v98, v98, v246, vcc
  v_add_u32 v245, 3, v244
  v_cmp_gt_u32 vcc, v245, v5
  v_cndmask_b32 v99, v99, v246, vcc
  v_add_u32 v245, 8, v244
  v_cmp_gt_u32 vcc, v245, v5
  v_cndmask_b32 v100, v100, v246, vcc
  v_add_u32 v245, 9, v244
  v_cmp_gt_u32 vcc, v245, v5
  v_cndmask_b32 v101, v101, v246, vcc
  v_add_u32 v245, 10, v244
  v_cmp_gt_u32 vcc, v245, v5
  v_cndmask_b32 v102, v102, v246, vcc
  v_add_u32 v245, 11, v244
  v_cmp_gt_u32 vcc, v245, v5
  v_cndmask_b32 v103, v103, v246, vcc
  v_add_u32 v245, 16, v244
  v_cmp_gt_u32 vcc, v245, v5
  v_cndmask_b32 v104, v104, v246, vcc
  v_add_u32 v245, 17, v244
  v_cmp_gt_u32 vcc, v245, v5
  v_cndmask_b32 v105, v105, v246, vcc
  v_add_u32 v245, 18, v244
  v_cmp_gt_u32 vcc, v245, v5
  v_cndmask_b32 v106, v106, v246, vcc
  v_add_u32 v245, 19, v244
  v_cmp_gt_u32 vcc, v245, v5
  v_cndmask_b32 v107, v107, v246, vcc
  v_add_u32 v245, 24, v244
  v_cmp_gt_u32 vcc, v245, v5
  v_cndmask_b32 v108, v108, v246, vcc
  v_add_u32 v245, 25, v244
  v_cmp_gt_u32 vcc, v245, v5
  v_cndmask_b32 v109, v109, v246, vcc
  v_add_u32 v245, 26, v244
  v_cmp_gt_u32 vcc, v245, v5
  v_cndmask_b32 v110, v110, v246, vcc
  v_add_u32 v245, 27, v244
  v_cmp_gt_u32 vcc, v245, v5
  v_cndmask_b32 v111, v111, v246, vcc
  v_add_u32 v245, 32, v244
  v_cmp_gt_u32 vcc, v245, v5
  v_cndmask_b32 v112, v112, v246, vcc
  v_add_u32 v245, 33, v244
  v_cmp_gt_u32 vcc, v245, v5
  v_cndmask_b32 v113, v113, v246, vcc
  v_add_u32 v245, 34, v244
  v_cmp_gt_u32 vcc, v245, v5
  v_cndmask_b32 v114, v114, v246, vcc
  v_add_u32 v245, 35, v244
  v_cmp_gt_u32 vcc, v245, v5
  v_cndmask_b32 v115, v115, v246, vcc
  v_add_u32 v245, 40, v244
  v_cmp_gt_u32 vcc, v245, v5
  v_cndmask_b32 v116, v116, v246, vcc
  v_add_u32 v245, 41, v244
  v_cmp_gt_u32 vcc, v245, v5
  v_cndmask_b32 v117, v117, v246, vcc
  v_add_u32 v245, 42, v244
  v_cmp_gt_u32 vcc, v245, v5
  v_cndmask_b32 v118, v118, v246, vcc
  v_add_u32 v245, 43, v244
  v_cmp_gt_u32 vcc, v245, v5
  v_cndmask_b32 v119, v119, v246, vcc
  v_add_u32 v245, 48, v244
  v_cmp_gt_u32 vcc, v245, v5
  v_cndmask_b32 v120, v120, v246, vcc
  v_add_u32 v245, 49, v244
  v_cmp_gt_u32 vcc, v245, v5
  v_cndmask_b32 v121, v121, v246, vcc
  v_add_u32 v245, 50, v244
  v_cmp_gt_u32 vcc, v245, v5
  v_cndmask_b32 v122, v122, v246, vcc
  v_add_u32 v245, 51, v244
  v_cmp_gt_u32 vcc, v245, v5
  v_cndmask_b32 v123, v123, v246, vcc
  v_add_u32 v245, 56, v244
  v_cmp_gt_u32 vcc, v245, v5
  v_cndmask_b32 v124, v124, v246, vcc
  v_add_u32 v245, 57, v244
  v_cmp_gt_u32 vcc, v245, v5
  v_cndmask_b32 v125, v125, v246, vcc
  v_add_u32 v245, 58, v244
  v_cmp_gt_u32 vcc, v245, v5
  v_cndmask_b32 v126, v126, v246, vcc
  v_add_u32 v245, 59, v244
  v_cmp_gt_u32 vcc, v245, v5
  v_cndmask_b32 v127, v127, v246, vcc
L_attn_kernel_nm0:
  s_waitcnt vmcnt(0) lgkmcnt(0)
  s_barrier
  s_add_u32 m0, s53, 32768
  s_add_u32 s26, s24, 0
  buffer_load_dwordx4 v10, s[8:11], s26 offen lds
  s_add_u32 m0, s53, 36864
  s_add_u32 s26, s24, 131072
  buffer_load_dwordx4 v10, s[8:11], s26 offen lds
  s_add_u32 m0, s53, 40960
  s_add_u32 s26, s24, 262144
  buffer_load_dwordx4 v10, s[8:11], s26 offen lds
  s_add_u32 m0, s53, 45056
  s_add_u32 s26, s24, 393216
  buffer_load_dwordx4 v10, s[8:11], s26 offen lds
  s_add_u32 s24, s24, 524288
  s_add_u32 m0, s53, 16384
  s_add_u32 s26, s25, 0
  buffer_load_dwordx4 v11, s[12:15], s26 offen lds
  s_add_u32 m0, s53, 20480
  s_add_u32 s26, s25, 131072
  buffer_load_dwordx4 v11, s[12:15], s26 offen lds
  s_add_u32 m0, s53, 24576
  s_add_u32 s26, s25, 262144
  buffer_load_dwordx4 v11, s[12:15], s26 offen lds
  s_add_u32 m0, s53, 28672
  s_add_u32 s26, s25, 393216
  buffer_load_dwordx4 v11, s[12:15], s26 offen lds
  s_add_u32 s25, s25, 524288
  v_max3_f32 v243, v96, v97, v98
  v_max3_f32 v243, v243, v99, v100
  v_max3_f32 v243, v243, v101, v102
  v_max3_f32 v243, v243, v103, v104
  v_max3_f32 v243, v243, v105, v106
  v_max3_f32 v243, v243, v107, v108
  v_max3_f32 v243, v243, v109, v110
  v_max3_f32 v243, v243, v111, v112
  v_max3_f32 v243, v243, v113, v114
  v_max3_f32 v243, v243, v115, v116
  v_max3_f32 v243, v243, v117, v118
  v_max3_f32 v243, v243, v119, v120
  v_max3_f32 v243, v243, v121, v122
  v_max3_f32 v243, v243, v123, v124
  v_max3_f32 v243, v243, v125, v126
  v_max_f32 v243, v243, v127
  v_mov_b32 v244, v243
  s_nop 1
  v_permlane32_swap_b32 v244, v243
  s_nop 1
  ds_read_b128 v[208:211], v16 offset:0
  ds_read_b128 v[212:215], v17 offset:0
  ds_read_b128 v[216:219], v18 offset:0
  ds_read_b128 v[220:223], v19 offset:0
  ds_read_b128 v[224:227], v20 offset:0
  ds_read_b128 v[228:231], v21 offset:0
  ds_read_b128 v[232:235], v22 offset:0
  ds_read_b128 v[236:239], v23 offset:0
  s_waitcnt lgkmcnt(7)
  v_mfma_f32_32x32x16_bf16 v[64:79], v[208:211], v[32:35], 0
  v_max3_f32 v243, v243, v244, v240
  v_sub_f32 v244, v240, v243
  v_mul_f32 v244, s31, v244
  v_exp_f32 v244, v244
  v_mov_b32 v240, v243
  v_mul_f32 v245, s31, v243
  v_fma_f32 v96, v96, s31, -v245
  v_exp_f32 v96, v96
  v_fma_f32 v97, v97, s31, -v245
  v_exp_f32 v97, v97
  v_fma_f32 v98, v98, s31, -v245
  ds_read_b128 v[208:211], v16 offset:8192
  s_waitcnt lgkmcnt(7)
  v_mfma_f32_32x32x16_bf16 v[64:79], v[212:215], v[36:39], v[64:79]
  v_exp_f32 v98, v98
  v_fma_f32 v99, v99, s31, -v245
  v_exp_f32 v99, v99
  v_fma_f32 v100, v100, s31, -v245
  v_exp_f32 v100, v100
  v_fma_f32 v101, v101, s31, -v245
  v_exp_f32 v101, v101
  v_fma_f32 v102, v102, s31, -v245
  v_exp_f32 v102, v102
  v_fma_f32 v103, v103, s31, -v245
  v_exp_f32 v103, v103
  ds_read_b128 v[212:215], v17 offset:8192
  s_waitcnt lgkmcnt(7)
  v_mfma_f32_32x32x16_bf16 v[64:79], v[216:219], v[40:43], v[64:79]
  v_fma_f32 v104, v104, s31, -v245
  v_exp_f32 v104, v104
  v_fma_f32 v105, v105, s31, -v245
  v_exp_f32 v105, v105
  v_fma_f32 v106, v106, s31, -v245
  v_exp_f32 v106, v106
  v_fma_f32 v107, v107, s31, -v245
  v_exp_f32 v107, v107
  v_fma_f32 v108, v108, s31, -v245
  v_exp_f32 v108, v108
  v_fma_f32 v109, v109, s31, -v245
  v_exp_f32 v109, v109
  ds_read_b128 v[216:219], v18 offset:8192
  s_waitcnt lgkmcnt(7)
  v_mfma_f32_32x32x16_bf16 v[64:79], v[220:223], v[44:47], v[64:79]
  v_fma_f32 v110, v110, s31, -v245
  v_exp_f32 v110, v110
  v_fma_f32 v111, v111, s31, -v245
  v_exp_f32 v111, v111
  v_fma_f32 v112, v112, s31, -v245
  v_exp_f32 v112, v112
  v_fma_f32 v113, v113, s31, -v245
  v_exp_f32 v113, v113
  v_fma_f32 v114, v114, s31, -v245
  v_exp_f32 v114, v114
  v_fma_f32 v115, v115, s31, -v245
  ds_read_b128 v[220:223], v19 offset:8192
  s_waitcnt lgkmcnt(7)
  v_mfma_f32_32x32x16_bf16 v[64:79], v[224:227], v[48:51], v[64:79]
  v_exp_f32 v115, v115
  v_fma_f32 v116, v116, s31, -v245
  v_exp_f32 v116, v116
  v_fma_f32 v117, v117, s31, -v245
  v_exp_f32 v117, v117
  v_fma_f32 v118, v118, s31, -v245
  v_exp_f32 v118, v118
  v_fma_f32 v119, v119, s31, -v245
  v_exp_f32 v119, v119
  v_fma_f32 v120, v120, s31, -v245
  v_exp_f32 v120, v120
  v_fma_f32 v121, v121, s31, -v245
  ds_read_b128 v[224:227], v20 offset:8192
  s_waitcnt lgkmcnt(7)
  v_mfma_f32_32x32x16_bf16 v[64:79], v[228:231], v[52:55], v[64:79]
  v_exp_f32 v121, v121
  v_fma_f32 v122, v122, s31, -v245
  v_exp_f32 v122, v122
  v_fma_f32 v123, v123, s31, -v245
  v_exp_f32 v123, v123
  v_fma_f32 v124, v124, s31, -v245
  v_exp_f32 v124, v124
  v_fma_f32 v125, v125, s31, -v245
  v_exp_f32 v125, v125
  v_fma_f32 v126, v126, s31, -v245
  v_exp_f32 v126, v126
  ds_read_b128 v[228:231], v21 offset:8192
  s_waitcnt lgkmcnt(7)
  v_mfma_f32_32x32x16_bf16 v[64:79], v[232:235], v[56:59], v[64:79]
  v_fma_f32 v127, v127, s31, -v245
  v_exp_f32 v127, v127
  v_mul_f32 v241, v241, v244
  v_add_f32 v241, v241, v96
  v_add_f32 v241, v241, v97
  v_cvt_pk_bf16_f32 v128, v96, v97
  v_add_f32 v241, v241, v98
  v_add_f32 v241, v241, v99
  v_cvt_pk_bf16_f32 v129, v98, v99
  v_add_f32 v241, v241, v100
  v_add_f32 v241, v241, v101
  v_cvt_pk_bf16_f32 v130, v100, v101
  ds_read_b128 v[232:235], v22 offset:8192
  s_waitcnt lgkmcnt(7)
  v_mfma_f32_32x32x16_bf16 v[64:79], v[236:239], v[60:63], v[64:79]
  v_add_f32 v241, v241, v102
  v_add_f32 v241, v241, v103
  v_cvt_pk_bf16_f32 v131, v102, v103
  v_add_f32 v241, v241, v104
  v_add_f32 v241, v241, v105
  v_cvt_pk_bf16_f32 v132, v104, v105
  v_add_f32 v241, v241, v106
  v_add_f32 v241, v241, v107
  v_cvt_pk_bf16_f32 v133, v106, v107
  v_add_f32 v241, v241, v108
  v_add_f32 v241, v241, v109
  ds_read_b128 v[236:239], v23 offset:8192
  s_waitcnt lgkmcnt(7)
  v_mfma_f32_32x32x16_bf16 v[80:95], v[208:211], v[32:35], 0
  v_cvt_pk_bf16_f32 v134, v108, v109
  v_add_f32 v241, v241, v110
  v_add_f32 v241, v241, v111
  v_cvt_pk_bf16_f32 v135, v110, v111
  v_add_f32 v241, v241, v112
  v_add_f32 v241, v241, v113
  v_cvt_pk_bf16_f32 v136, v112, v113
  v_add_f32 v241, v241, v114
  v_add_f32 v241, v241, v115
  v_cvt_pk_bf16_f32 v137, v114, v115
  v_add_f32 v241, v241, v116
  s_waitcnt lgkmcnt(6)
  v_mfma_f32_32x32x16_bf16 v[80:95], v[212:215], v[36:39], v[80:95]
  v_add_f32 v241, v241, v117
  v_cvt_pk_bf16_f32 v138, v116, v117
  v_add_f32 v241, v241, v118
  v_add_f32 v241, v241, v119
  v_cvt_pk_bf16_f32 v139, v118, v119
  v_add_f32 v241, v241, v120
  v_add_f32 v241, v241, v121
  v_cvt_pk_bf16_f32 v140, v120, v121
  v_add_f32 v241, v241, v122
  v_add_f32 v241, v241, v123
  v_cvt_pk_bf16_f32 v141, v122, v123
  v_add_f32 v241, v241, v124
  s_waitcnt lgkmcnt(5)
  v_mfma_f32_32x32x16_bf16 v[80:95], v[216:219], v[40:43], v[80:95]
  v_add_f32 v241, v241, v125
  v_cvt_pk_bf16_f32 v142, v124, v125
  v_add_f32 v241, v241, v126
  v_add_f32 v241, v241, v127
  v_cvt_pk_bf16_f32 v143, v126, v127
  v_mul_f32 v144, v144, v244
  v_mul_f32 v145, v145, v244
  v_mul_f32 v146, v146, v244
  v_mul_f32 v147, v147, v244
  v_mul_f32 v148, v148, v244
  v_mul_f32 v149, v149, v244
  s_waitcnt lgkmcnt(4)
  v_mfma_f32_32x32x16_bf16 v[80:95], v[220:223], v[44:47], v[80:95]
  v_mul_f32 v150, v150, v244
  v_mul_f32 v151, v151, v244
  v_mul_f32 v152, v152, v244
  v_mul_f32 v153, v153, v244
  v_mul_f32 v154, v154, v244
  v_mul_f32 v155, v155, v244
  v_mul_f32 v156, v156, v244
  v_mul_f32 v157, v157, v244
  v_mul_f32 v158, v158, v244
  v_mul_f32 v159, v159, v244
  v_mul_f32 v160, v160, v244
  v_mul_f32 v161, v161, v244
  s_waitcnt lgkmcnt(3)
  v_mfma_f32_32x32x16_bf16 v[80:95], v[224:227], v[48:51], v[80:95]
  v_mul_f32 v162, v162, v244
  v_mul_f32 v163, v163, v244
  v_mul_f32 v164, v164, v244
  v_mul_f32 v165, v165, v244
  v_mul_f32 v166, v166, v244
  v_mul_f32 v167, v167, v244
  v_mul_f32 v168, v168, v244
  v_mul_f32 v169, v169, v244
  v_mul_f32 v170, v170, v244
  v_mul_f32 v171, v171, v244
  v_mul_f32 v172, v172, v244
  s_waitcnt lgkmcnt(2)
  v_mfma_f32_32x32x16_bf16 v[80:95], v[228:231], v[52:55], v[80:95]
  v_mul_f32 v173, v173, v244
  v_mul_f32 v174, v174, v244
  v_mul_f32 v175, v175, v244
  v_mul_f32 v176, v176, v244
  v_mul_f32 v177, v177, v244
  v_mul_f32 v178, v178, v244
  v_mul_f32 v179, v179, v244
  v_mul_f32 v180, v180, v244
  v_mul_f32 v181, v181, v244
  v_mul_f32 v182, v182, v244
  v_mul_f32 v183, v183, v244
  v_mul_f32 v184, v184, v244
  s_waitcnt lgkmcnt(1)
  v_mfma_f32_32x32x16_bf16 v[80:95], v[232:235], v[56:59], v[80:95]
  v_mul_f32 v185, v185, v244
  v_mul_f32 v186, v186, v244
  v_mul_f32 v187, v187, v244
  v_mul_f32 v188, v188, v244
  v_mul_f32 v189, v189, v244
  v_mul_f32 v190, v190, v244
  v_mul_f32 v191, v191, v244
  v_mul_f32 v192, v192, v244
  v_mul_f32 v193, v193, v244
  v_mul_f32 v194, v194, v244
  v_mul_f32 v195, v195, v244
  s_waitcnt lgkmcnt(0)
  v_mfma_f32_32x32x16_bf16 v[80:95], v[236:239], v[60:63], v[80:95]
  v_mul_f32 v196, v196, v244
  v_mul_f32 v197, v197, v244
  v_mul_f32 v198, v198, v244
  v_mul_f32 v199, v199, v244
  v_mul_f32 v200, v200, v244
  v_mul_f32 v201, v201, v244
  v_mul_f32 v202, v202, v244
  v_mul_f32 v203, v203, v244
  v_mul_f32 v204, v204, v244
  v_mul_f32 v205, v205, v244
  v_mul_f32 v206, v206, v244
  v_mul_f32 v207, v207, v244
  s_nop 1
  ds_read_b64_tr_b16 v[208:209], v24 offset:32768
  ds_read_b64_tr_b16 v[210:211], v24 offset:34816
  ds_read_b64_tr_b16 v[212:213], v24 offset:36864
  ds_read_b64_tr_b16 v[214:215], v24 offset:38912
  ds_read_b64_tr_b16 v[216:217], v24 offset:40960
  ds_read_b64_tr_b16 v[218:219], v24 offset:43008
  ds_read_b64_tr_b16 v[220:221], v24 offset:45056
  ds_read_b64_tr_b16 v[222:223], v24 offset:47104
  ds_read_b64_tr_b16 v[224:225], v25 offset:32768
  ds_read_b64_tr_b16 v[226:227], v25 offset:34816
  ds_read_b64_tr_b16 v[228:229], v25 offset:36864
  ds_read_b64_tr_b16 v[230:231], v25 offset:38912
  ds_read_b64_tr_b16 v[232:233], v25 offset:40960
  ds_read_b64_tr_b16 v[234:235], v25 offset:43008
  ds_read_b64_tr_b16 v[236:237], v25 offset:45056
  ds_read_b64_tr_b16 v[238:239], v25 offset:47104
  s_waitcnt lgkmcnt(14)
  v_mfma_f32_32x32x16_bf16 v[144:159], v[208:211], v[128:131], v[144:159]
  v_cvt_pk_bf16_f32 v64, v64, v65
  v_and_b32 v65, 0xffff0000, v64
  v_lshlrev_b32 v64, 16, v64
  v_mul_f32 v64, s30, v64
  v_mul_f32 v65, s30, v65
  v_cvt_pk_bf16_f32 v64, v64, v65
  v_and_b32 v65, 0xffff0000, v64
  v_lshlrev_b32 v64, 16, v64
  ds_read_b64_tr_b16 v[208:209], v26 offset:32768
  ds_read_b64_tr_b16 v[210:211], v26 offset:34816
  s_waitcnt lgkmcnt(14)
  v_mfma_f32_32x32x16_bf16 v[144:159], v[212:215], v[132:135], v[144:159]
  v_cvt_pk_bf16_f32 v66, v66, v67
  v_and_b32 v67, 0xffff0000, v66
  v_lshlrev_b32 v66, 16, v66
  v_mul_f32 v66, s30, v66
  v_mul_f32 v67, s30, v67
  v_cvt_pk_bf16_f32 v66, v66, v67
  v_and_b32 v67, 0xffff0000, v66
  v_lshlrev_b32 v66, 16, v66
  ds_read_b64_tr_b16 v[212:213], v26 offset:36864
  ds_read_b64_tr_b16 v[214:215], v26 offset:38912
  s_waitcnt lgkmcnt(14)
  v_mfma_f32_32x32x16_bf16 v[144:159], v[216:219], v[136:139], v[144:159]
  v_cvt_pk_bf16_f32 v68, v68, v69
  v_and_b32 v69, 0xffff0000, v68
  v_lshlrev_b32 v68, 16, v68
  v_mul_f32 v68, s30, v68
  v_mul_f32 v69, s30, v69
  v_cvt_pk_bf16_f32 v68, v68, v69
  v_and_b32 v69, 0xffff0000, v68
  v_lshlrev_b32 v68, 16, v68
  ds_read_b64_tr_b16 v[216:217], v26 offset:40960
  ds_read_b64_tr_b16 v[218:219], v26 offset:43008
  s_waitcnt lgkmcnt(14)
  v_mfma_f32_32x32x16_bf16 v[144:159], v[220:223], v[140:143], v[144:159]
  v_cvt_pk_bf16_f32 v70, v70, v71
  v_and_b32 v71, 0xffff0000, v70
  v_lshlrev_b32 v70, 16, v70
  v_mul_f32 v70, s30, v70
  v_mul_f32 v71, s30, v71
  v_cvt_pk_bf16_f32 v70, v70, v71
  v_and_b32 v71, 0xffff0000, v70
  v_lshlrev_b32 v70, 16, v70
  ds_read_b64_tr_b16 v[220:221], v26 offset:45056
  ds_read_b64_tr_b16 v[222:223], v26 offset:47104
  s_waitcnt lgkmcnt(14)
  v_mfma_f32_32x32x16_bf16 v[160:175], v[224:227], v[128:131], v[160:175]
  v_cvt_pk_bf16_f32 v72, v72, v73
  v_and_b32 v73, 0xffff0000, v72
  v_lshlrev_b32 v72, 16, v72
  v_mul_f32 v72, s30, v72
  v_mul_f32 v73, s30, v73
  v_cvt_pk_bf16_f32 v72, v72, v73
  v_and_b32 v73, 0xffff0000, v72
  v_lshlrev_b32 v72, 16, v72
  ds_read_b64_tr_b16 v[224:225], v27 offset:32768
  ds_read_b64_tr_b16 v[226:227], v27 offset:34816
  s_waitcnt lgkmcnt(14)
  v_mfma_f32_32x32x16_bf16 v[160:175], v[228:231], v[132:135], v[160:175]
  v_cvt_pk_bf16_f32 v74, v74, v75
  v_and_b32 v75, 0xffff0000, v74
  v_lshlrev_b32 v74, 16, v74
  v_mul_f32 v74, s30, v74
  v_mul_f32 v75, s30, v75
  v_cvt_pk_bf16_f32 v74, v74, v75
  v_and_b32 v75, 0xffff0000, v74
  v_lshlrev_b32 v74, 16, v74
  ds_read_b64_tr_b16 v[228:229], v27 offset:36864
  ds_read_b64_tr_b16 v[230:231], v27 offset:38912
  s_waitcnt lgkmcnt(14)
  v_mfma_f32_32x32x16_bf16 v[160:175], v[232:235], v[136:139], v[160:175]
  v_cvt_pk_bf16_f32 v76, v76, v77
  v_and_b32 v77, 0xffff0000, v76
  v_lshlrev_b32 v76, 16, v76
  v_mul_f32 v76, s30, v76
  v_mul_f32 v77, s30, v77
  v_cvt_pk_bf16_f32 v76, v76, v77
  v_and_b32 v77, 0xffff0000, v76
  v_lshlrev_b32 v76, 16, v76
  ds_read_b64_tr_b16 v[232:233], v27 offset:40960
  ds_read_b64_tr_b16 v[234:235], v27 offset:43008
  s_waitcnt lgkmcnt(14)
  v_mfma_f32_32x32x16_bf16 v[160:175], v[236:239], v[140:143], v[160:175]
  v_cvt_pk_bf16_f32 v78, v78, v79
  v_and_b32 v79, 0xffff0000, v78
  v_lshlrev_b32 v78, 16, v78
  v_mul_f32 v78, s30, v78
  v_mul_f32 v79, s30, v79
  v_cvt_pk_bf16_f32 v78, v78, v79
  v_and_b32 v79, 0xffff0000, v78
  v_lshlrev_b32 v78, 16, v78
  ds_read_b64_tr_b16 v[236:237], v27 offset:45056
  ds_read_b64_tr_b16 v[238:239], v27 offset:47104
  s_waitcnt lgkmcnt(14)
  v_mfma_f32_32x32x16_bf16 v[176:191], v[208:211], v[128:131], v[176:191]
  v_cvt_pk_bf16_f32 v80, v80, v81
  v_and_b32 v81, 0xffff0000, v80
  v_lshlrev_b32 v80, 16, v80
  v_mul_f32 v80, s30, v80
  v_mul_f32 v81, s30, v81
  v_cvt_pk_bf16_f32 v80, v80, v81
  v_and_b32 v81, 0xffff0000, v80
  v_lshlrev_b32 v80, 16, v80
  s_waitcnt lgkmcnt(12)
  v_mfma_f32_32x32x16_bf16 v[176:191], v[212:215], v[132:135], v[176:191]
  v_cvt_pk_bf16_f32 v82, v82, v83
  v_and_b32 v83, 0xffff0000, v82
  v_lshlrev_b32 v82, 16, v82
  v_mul_f32 v82, s30, v82
  v_mul_f32 v83, s30, v83
  v_cvt_pk_bf16_f32 v82, v82, v83
  v_and_b32 v83, 0xffff0000, v82
  v_lshlrev_b32 v82, 16, v82
  s_waitcnt lgkmcnt(10)
  v_mfma_f32_32x32x16_bf16 v[176:191], v[216:219], v[136:139], v[176:191]
  v_cvt_pk_bf16_f32 v84, v84, v85
  v_and_b32 v85, 0xffff0000, v84
  v_lshlrev_b32 v84, 16, v84
  v_mul_f32 v84, s30, v84
  v_mul_f32 v85, s30, v85
  v_cvt_pk_bf16_f32 v84, v84, v85
  v_and_b32 v85, 0xffff0000, v84
  v_lshlrev_b32 v84, 16, v84
  s_waitcnt lgkmcnt(8)
  v_mfma_f32_32x32x16_bf16 v[176:191], v[220:223], v[140:143], v[176:191]
  v_cvt_pk_bf16_f32 v86, v86, v87
  v_and_b32 v87, 0xffff0000, v86
  v_lshlrev_b32 v86, 16, v86
  v_mul_f32 v86, s30, v86
  v_mul_f32 v87, s30, v87
  v_cvt_pk_bf16_f32 v86, v86, v87
  v_and_b32 v87, 0xffff0000, v86
  v_lshlrev_b32 v86, 16, v86
  s_waitcnt lgkmcnt(6)
  v_mfma_f32_32x32x16_bf16 v[192:207], v[224:227], v[128:131], v[192:207]
  v_cvt_pk_bf16_f32 v88, v88, v89
  v_and_b32 v89, 0xffff0000, v88
  v_lshlrev_b32 v88, 16, v88
  v_mul_f32 v88, s30, v88
  v_mul_f32 v89, s30, v89
  v_cvt_pk_bf16_f32 v88, v88, v89
  v_and_b32 v89, 0xffff0000, v88
  v_lshlrev_b32 v88, 16, v88
  s_waitcnt lgkmcnt(4)
  v_mfma_f32_32x32x16_bf16 v[192:207], v[228:231], v[132:135], v[192:207]
  v_cvt_pk_bf16_f32 v90, v90, v91
  v_and_b32 v91, 0xffff0000, v90
  v_lshlrev_b32 v90, 16, v90
  v_mul_f32 v90, s30, v90
  v_mul_f32 v91, s30, v91
  v_cvt_pk_bf16_f32 v90, v90, v91
  v_and_b32 v91, 0xffff0000, v90
  v_lshlrev_b32 v90, 16, v90
  s_waitcnt lgkmcnt(2)
  v_mfma_f32_32x32x16_bf16 v[192:207], v[232:235], v[136:139], v[192:207]
  v_cvt_pk_bf16_f32 v92, v92, v93
  v_and_b32 v93, 0xffff0000, v92
  v_lshlrev_b32 v92, 16, v92
  v_mul_f32 v92, s30, v92
  v_mul_f32 v93, s30, v93
  v_cvt_pk_bf16_f32 v92, v92, v93
  v_and_b32 v93, 0xffff0000, v92
  v_lshlrev_b32 v92, 16, v92
  s_waitcnt lgkmcnt(0)
  v_mfma_f32_32x32x16_bf16 v[192:207], v[236:239], v[140:143], v[192:207]
  v_cvt_pk_bf16_f32 v94, v94, v95
  v_and_b32 v95, 0xffff0000, v94
  v_lshlrev_b32 v94, 16, v94
  v_mul_f32 v94, s30, v94
  v_mul_f32 v95, s30, v95
  v_cvt_pk_bf16_f32 v94, v94, v95
  v_and_b32 v95, 0xffff0000, v94
  v_lshlrev_b32 v94, 16, v94
  s_add_u32 s21, s21, 64
  s_add_u32 s26, s21, 63
  s_cmp_le_u32 s26, s18
  s_cbranch_scc1 L_attn_kernel_nm1
  v_lshlrev_b32 v244, 2, v4
  v_add_u32 v244, s21, v244

  v_add_u32 v245, 0, v244
  v_cmp_gt_u32 vcc, v245, v5
  v_cndmask_b32 v64, v64, v246, vcc
  v_add_u32 v245, 1, v244
  v_cmp_gt_u32 vcc, v245, v5
  v_cndmask_b32 v65, v65, v246, vcc
  v_add_u32 v245, 2, v244
  v_cmp_gt_u32 vcc, v245, v5
  v_cndmask_b32 v66, v66, v246, vcc
  v_add_u32 v245, 3, v244
  v_cmp_gt_u32 vcc, v245, v5
  v_cndmask_b32 v67, v67, v246, vcc
  v_add_u32 v245, 8, v244
  v_cmp_gt_u32 vcc, v245, v5
  v_cndmask_b32 v68, v68, v246, vcc
  v_add_u32 v245, 9, v244
  v_cmp_gt_u32 vcc, v245, v5
  v_cndmask_b32 v69, v69, v246, vcc
  v_add_u32 v245, 10, v244
  v_cmp_gt_u32 vcc, v245, v5
  v_cndmask_b32 v70, v70, v246, vcc
  v_add_u32 v245, 11, v244
  v_cmp_gt_u32 vcc, v245, v5
  v_cndmask_b32 v71, v71, v246, vcc
  v_add_u32 v245, 16, v244
  v_cmp_gt_u32 vcc, v245, v5
  v_cndmask_b32 v72, v72, v246, vcc
  v_add_u32 v245, 17, v244
  v_cmp_gt_u32 vcc, v245, v5
  v_cndmask_b32 v73, v73, v246, vcc
  v_add_u32 v245, 18, v244
  v_cmp_gt_u32 vcc, v245, v5
  v_cndmask_b32 v74, v74, v246, vcc
  v_add_u32 v245, 19, v244
  v_cmp_gt_u32 vcc, v245, v5
  v_cndmask_b32 v75, v75, v246, vcc
  v_add_u32 v245, 24, v244
  v_cmp_gt_u32 vcc, v245, v5
  v_cndmask_b32 v76, v76, v246, vcc
  v_add_u32 v245, 25, v244
  v_cmp_gt_u32 vcc, v245, v5
  v_cndmask_b32 v77, v77, v246, vcc
  v_add_u32 v245, 26, v244
  v_cmp_gt_u32 vcc, v245, v5
  v_cndmask_b32 v78, v78, v246, vcc
  v_add_u32 v245, 27, v244
  v_cmp_gt_u32 vcc, v245, v5
  v_cndmask_b32 v79, v79, v246, vcc
  v_add_u32 v245, 32, v244
  v_cmp_gt_u32 vcc, v245, v5
  v_cndmask_b32 v80, v80, v246, vcc
  v_add_u32 v245, 33, v244
  v_cmp_gt_u32 vcc, v245, v5
  v_cndmask_b32 v81, v81, v246, vcc
  v_add_u32 v245, 34, v244
  v_cmp_gt_u32 vcc, v245, v5
  v_cndmask_b32 v82, v82, v246, vcc
  v_add_u32 v245, 35, v244
  v_cmp_gt_u32 vcc, v245, v5
  v_cndmask_b32 v83, v83, v246, vcc
  v_add_u32 v245, 40, v244
  v_cmp_gt_u32 vcc, v245, v5
  v_cndmask_b32 v84, v84, v246, vcc
  v_add_u32 v245, 41, v244
  v_cmp_gt_u32 vcc, v245, v5
  v_cndmask_b32 v85, v85, v246, vcc
  v_add_u32 v245, 42, v244
  v_cmp_gt_u32 vcc, v245, v5
  v_cndmask_b32 v86, v86, v246, vcc
  v_add_u32 v245, 43, v244
  v_cmp_gt_u32 vcc, v245, v5
  v_cndmask_b32 v87, v87, v246, vcc
  v_add_u32 v245, 48, v244
  v_cmp_gt_u32 vcc, v245, v5
  v_cndmask_b32 v88, v88, v246, vcc
  v_add_u32 v245, 49, v244
  v_cmp_gt_u32 vcc, v245, v5
  v_cndmask_b32 v89, v89, v246, vcc
  v_add_u32 v245, 50, v244
  v_cmp_gt_u32 vcc, v245, v5
  v_cndmask_b32 v90, v90, v246, vcc
  v_add_u32 v245, 51, v244
  v_cmp_gt_u32 vcc, v245, v5
  v_cndmask_b32 v91, v91, v246, vcc
  v_add_u32 v245, 56, v244
  v_cmp_gt_u32 vcc, v245, v5
  v_cndmask_b32 v92, v92, v246, vcc
  v_add_u32 v245, 57, v244
  v_cmp_gt_u32 vcc, v245, v5
  v_cndmask_b32 v93, v93, v246, vcc
  v_add_u32 v245, 58, v244
  v_cmp_gt_u32 vcc, v245, v5
  v_cndmask_b32 v94, v94, v246, vcc
  v_add_u32 v245, 59, v244
  v_cmp_gt_u32 vcc, v245, v5
  v_cndmask_b32 v95, v95, v246, vcc
L_attn_kernel_nm1:
  s_waitcnt vmcnt(0) lgkmcnt(0)
  s_barrier
  s_sub_u32 s22, s22, 2
  s_cmp_lg_u32 s22, 0
  s_cbranch_scc1 L_attn_kernel_loop
  s_nop 7
  s_nop 7
  v_mov_b32 v244, v241
  s_nop 1
  v_permlane32_swap_b32 v244, v241
  s_nop 1
  v_add_f32 v241, v241, v244
  v_rcp_f32 v243, v241
  s_nop 7
  s_nop 7
  v_fma_f32 v244, -v243, v241, 1.0
  v_fmac_f32 v243, v244, v243
  v_lshlrev_b32 v6, 13, v5
  v_lshl_add_u32 v6, v4, 3, v6

  v_mul_f32 v144, v144, v243
  v_mul_f32 v145, v145, v243
  v_mul_f32 v146, v146, v243
  v_mul_f32 v147, v147, v243
  v_cvt_pk_bf16_f32 v244, v144, v145
  v_cvt_pk_bf16_f32 v245, v146, v147
  buffer_store_dwordx2 v[244:245], v6, s[44:47], 0 offen offset:0
  s_nop 1
  v_mul_f32 v148, v148, v243
  v_mul_f32 v149, v149, v243
  v_mul_f32 v150, v150, v243
  v_mul_f32 v151, v151, v243
  v_cvt_pk_bf16_f32 v244, v148, v149
  v_cvt_pk_bf16_f32 v245, v150, v151
  buffer_store_dwordx2 v[244:245], v6, s[44:47], 0 offen offset:16
  s_nop 1
  v_mul_f32 v152, v152, v243
  v_mul_f32 v153, v153, v243
  v_mul_f32 v154, v154, v243
  v_mul_f32 v155, v155, v243
  v_cvt_pk_bf16_f32 v244, v152, v153
  v_cvt_pk_bf16_f32 v245, v154, v155
  buffer_store_dwordx2 v[244:245], v6, s[44:47], 0 offen offset:32
  s_nop 1
  v_mul_f32 v156, v156, v243
  v_mul_f32 v157, v157, v243
  v_mul_f32 v158, v158, v243
  v_mul_f32 v159, v159, v243
  v_cvt_pk_bf16_f32 v244, v156, v157
  v_cvt_pk_bf16_f32 v245, v158, v159
  buffer_store_dwordx2 v[244:245], v6, s[44:47], 0 offen offset:48
  s_nop 1
  v_mul_f32 v160, v160, v243
  v_mul_f32 v161, v161, v243
  v_mul_f32 v162, v162, v243
  v_mul_f32 v163, v163, v243
  v_cvt_pk_bf16_f32 v244, v160, v161
  v_cvt_pk_bf16_f32 v245, v162, v163
  buffer_store_dwordx2 v[244:245], v6, s[44:47], 0 offen offset:64
  s_nop 1
  v_mul_f32 v164, v164, v243
  v_mul_f32 v165, v165, v243
  v_mul_f32 v166, v166, v243
  v_mul_f32 v167, v167, v243
  v_cvt_pk_bf16_f32 v244, v164, v165
  v_cvt_pk_bf16_f32 v245, v166, v167
  buffer_store_dwordx2 v[244:245], v6, s[44:47], 0 offen offset:80
  s_nop 1
  v_mul_f32 v168, v168, v243
  v_mul_f32 v169, v169, v243
  v_mul_f32 v170, v170, v243
  v_mul_f32 v171, v171, v243
  v_cvt_pk_bf16_f32 v244, v168, v169
  v_cvt_pk_bf16_f32 v245, v170, v171
  buffer_store_dwordx2 v[244:245], v6, s[44:47], 0 offen offset:96
  s_nop 1
  v_mul_f32 v172, v172, v243
  v_mul_f32 v173, v173, v243
  v_mul_f32 v174, v174, v243
  v_mul_f32 v175, v175, v243
  v_cvt_pk_bf16_f32 v244, v172, v173
  v_cvt_pk_bf16_f32 v245, v174, v175
  buffer_store_dwordx2 v[244:245], v6, s[44:47], 0 offen offset:112
  s_nop 1
  v_mul_f32 v176, v176, v243
  v_mul_f32 v177, v177, v243
  v_mul_f32 v178, v178, v243
  v_mul_f32 v179, v179, v243
  v_cvt_pk_bf16_f32 v244, v176, v177
  v_cvt_pk_bf16_f32 v245, v178, v179
  buffer_store_dwordx2 v[244:245], v6, s[44:47], 0 offen offset:128
  s_nop 1
  v_mul_f32 v180, v180, v243
  v_mul_f32 v181, v181, v243
  v_mul_f32 v182, v182, v243
  v_mul_f32 v183, v183, v243
  v_cvt_pk_bf16_f32 v244, v180, v181
  v_cvt_pk_bf16_f32 v245, v182, v183
  buffer_store_dwordx2 v[244:245], v6, s[44:47], 0 offen offset:144
  s_nop 1
  v_mul_f32 v184, v184, v243
  v_mul_f32 v185, v185, v243
  v_mul_f32 v186, v186, v243
  v_mul_f32 v187, v187, v243
  v_cvt_pk_bf16_f32 v244, v184, v185
  v_cvt_pk_bf16_f32 v245, v186, v187
  buffer_store_dwordx2 v[244:245], v6, s[44:47], 0 offen offset:160
  s_nop 1
  v_mul_f32 v188, v188, v243
  v_mul_f32 v189, v189, v243
  v_mul_f32 v190, v190, v243
  v_mul_f32 v191, v191, v243
  v_cvt_pk_bf16_f32 v244, v188, v189
  v_cvt_pk_bf16_f32 v245, v190, v191
  buffer_store_dwordx2 v[244:245], v6, s[44:47], 0 offen offset:176
  s_nop 1
  v_mul_f32 v192, v192, v243
  v_mul_f32 v193, v193, v243
  v_mul_f32 v194, v194, v243
  v_mul_f32 v195, v195, v243
  v_cvt_pk_bf16_f32 v244, v192, v193
  v_cvt_pk_bf16_f32 v245, v194, v195
  buffer_store_dwordx2 v[244:245], v6, s[44:47], 0 offen offset:192
  s_nop 1
  v_mul_f32 v196, v196, v243
  v_mul_f32 v197, v197, v243
  v_mul_f32 v198, v198, v243
  v_mul_f32 v199, v199, v243
  v_cvt_pk_bf16_f32 v244, v196, v197
  v_cvt_pk_bf16_f32 v245, v198, v199
  buffer_store_dwordx2 v[244:245], v6, s[44:47], 0 offen offset:208
  s_nop 1
  v_mul_f32 v200, v200, v243
  v_mul_f32 v201, v201, v243
  v_mul_f32 v202, v202, v243
  v_mul_f32 v203, v203, v243
  v_cvt_pk_bf16_f32 v244, v200, v201
  v_cvt_pk_bf16_f32 v245, v202, v203
  buffer_store_dwordx2 v[244:245], v6, s[44:47], 0 offen offset:224
  s_nop 1
  v_mul_f32 v204, v204, v243
  v_mul_f32 v205, v205, v243
  v_mul_f32 v206, v206, v243
  v_mul_f32 v207, v207, v243
  v_cvt_pk_bf16_f32 v244, v204, v205
  v_cvt_pk_bf16_f32 v245, v206, v207
  buffer_store_dwordx2 v[244:245], v6, s[44:47], 0 offen offset:240
  s_nop 1
  s_mov_b32 s17, s61
  s_sub_u32 s62, s62, 1
  s_cmp_lg_u32 s62, 0

  s_cbranch_scc1 L_attn_kernel_blk
L_attn_kernel_done:
  s_endpgm
.section .rodata,"a"
.p2align 6
.amdhsa_kernel attn_kernel
  .amdhsa_next_free_vgpr 256
  .amdhsa_next_free_sgpr 96
  .amdhsa_accum_offset 256
  .amdhsa_group_segment_fixed_size 0
  .amdhsa_kernarg_size 112
  .amdhsa_user_sgpr_count 2
  .amdhsa_user_sgpr_kernarg_segment_ptr 1
  .amdhsa_system_sgpr_workgroup_id_x 1
.end_amdhsa_kernel
.text
.globl oproj_kernel
.p2align 8
.type oproj_kernel,@function
oproj_kernel:
  s_cmp_ge_u32 s2, 256
  s_cbranch_scc1 L_oproj_kernel_done
  s_load_dwordx2 s[32:33], s[0:1], 40
  s_load_dwordx2 s[40:41], s[0:1], 104
  s_and_b32 s16, s2, 3
  s_lshr_b32 s17, s2, 2
  s_and_b32 s17, s17, 15
  s_lshr_b32 s18, s2, 6
  s_waitcnt lgkmcnt(0)
  s_add_u32 s44, s40, 52428800
  s_addc_u32 s45, s41, 0
  s_lshl_b32 s19, s17, 20
  s_lshl_b32 s20, s18, 11
  s_add_u32 s19, s19, s20
  s_add_u32 s44, s44, s19
  s_addc_u32 s45, s45, 0

  s_mov_b32 s4, s44
  s_and_b32 s5, s45, 0xffff
  s_mov_b32 s6, 1048576
  s_mov_b32 s7, 0x00020000
  s_lshl_b32 s19, s16, 8
  s_lshl_b32 s20, s18, 20
  s_add_u32 s19, s19, s20
  s_add_u32 s46, s32, s19
  s_addc_u32 s47, s33, 0
  s_sub_u32 s20, 4194304, s19

  s_mov_b32 s8, s46
  s_and_b32 s9, s47, 0xffff
  s_mov_b32 s10, s20
  s_mov_b32 s11, 0x00020000
  s_lshl_b32 s20, s18, 22
  s_add_u32 s20, s20, 69206016
  s_lshl_b32 s21, s17, 18
  s_add_u32 s20, s20, s21
  s_lshl_b32 s21, s16, 9
  s_add_u32 s20, s20, s21
  s_add_u32 s44, s40, s20
  s_addc_u32 s45, s41, 0

  s_mov_b32 s12, s44
  s_and_b32 s13, s45, 0xffff
  s_mov_b32 s14, 262144
  s_mov_b32 s15, 0x00020000
  v_and_b32 v1, 63, v0
  v_lshrrev_b32 v2, 6, v0
  s_nop 1
  v_readfirstlane_b32 s50, v2
  v_lshrrev_b32 v5, 3, v1
  v_and_b32 v6, 7, v1
  v_lshrrev_b32 v7, 4, v1
  v_and_b32 v8, 1, v2
  v_lshl_add_u32 v8, v8, 2, v7
  v_xor_b32 v6, v6, v8
  v_mul_u32_u24 v3, 8192, v5
  v_lshl_add_u32 v3, v6, 4, v3
  v_and_b32 v6, 15, v1
  v_lshlrev_b32 v8, 2, v7
  v_xor_b32 v6, v6, v8
  v_mul_u32_u24 v4, 1024, v7
  v_lshl_add_u32 v4, v6, 4, v4

  v_and_b32 v1, 63, v0
  v_lshrrev_b32 v2, 6, v0
  v_lshrrev_b32 v7, 1, v2
  v_and_b32 v2, 1, v2
  v_and_b32 v8, 31, v1
  v_lshl_add_u32 v8, v7, 6, v8
  v_lshlrev_b32 v8, 7, v8
  v_lshrrev_b32 v9, 1, v1
  v_and_b32 v9, 7, v9
  v_lshrrev_b32 v10, 5, v1

  v_add_u32 v11, 0, v10
  v_xor_b32 v11, v11, v9
  v_lshl_add_u32 v12, v11, 4, v8

  v_add_u32 v11, 2, v10
  v_xor_b32 v11, v11, v9
  v_lshl_add_u32 v13, v11, 4, v8

  v_add_u32 v11, 4, v10
  v_xor_b32 v11, v11, v9
  v_lshl_add_u32 v14, v11, 4, v8

  v_add_u32 v11, 6, v10
  v_xor_b32 v11, v11, v9
  v_lshl_add_u32 v15, v11, 4, v8

  v_and_b32 v8, 15, v1
  v_lshrrev_b32 v9, 2, v8
  v_and_b32 v8, 3, v8
  v_lshrrev_b32 v7, 4, v1
  v_lshrrev_b32 v10, 1, v7
  v_lshlrev_b32 v10, 3, v10
  v_add_u32 v10, v10, v9
  v_lshlrev_b32 v10, 8, v10
  v_and_b32 v7, 1, v7
  v_lshlrev_b32 v7, 1, v7
  v_lshrrev_b32 v11, 1, v8
  v_add_u32 v7, v7, v11
  v_lshl_add_u32 v7, v2, 3, v7
  v_lshlrev_b32 v9, 2, v9
  v_and_b32 v8, 1, v8
  v_lshlrev_b32 v8, 3, v8
  v_add_u32 v10, v10, v8
  v_add_u32 v10, 16384, v10
  v_xor_b32 v11, v7, v9
  v_lshl_add_u32 v1, v11, 4, v10
  v_add_u32 v7, 4, v7
  v_xor_b32 v11, v7, v9
  v_lshl_add_u32 v2, v11, 4, v10
  v_mov_b32 v10, v1
  v_mov_b32 v11, v2

  v_add_u32 v144, 0x10000, v12
  v_add_u32 v145, 0x10000, v13
  v_add_u32 v146, 0x10000, v14
  v_add_u32 v147, 0x10000, v15
  v_add_u32 v148, 0x10000, v10
  v_add_u32 v149, 0x10000, v11
  v_mov_b32 v80, 0
  v_mov_b32 v81, 0
  v_mov_b32 v82, 0
  v_mov_b32 v83, 0
  v_mov_b32 v84, 0
  v_mov_b32 v85, 0
  v_mov_b32 v86, 0
  v_mov_b32 v87, 0
  v_mov_b32 v88, 0
  v_mov_b32 v89, 0
  v_mov_b32 v90, 0
  v_mov_b32 v91, 0
  v_mov_b32 v92, 0
  v_mov_b32 v93, 0
  v_mov_b32 v94, 0
  v_mov_b32 v95, 0
  v_mov_b32 v96, 0
  v_mov_b32 v97, 0
  v_mov_b32 v98, 0
  v_mov_b32 v99, 0
  v_mov_b32 v100, 0
  v_mov_b32 v101, 0
  v_mov_b32 v102, 0
  v_mov_b32 v103, 0
  v_mov_b32 v104, 0
  v_mov_b32 v105, 0
  v_mov_b32 v106, 0
  v_mov_b32 v107, 0
  v_mov_b32 v108, 0
  v_mov_b32 v109, 0
  v_mov_b32 v110, 0
  v_mov_b32 v111, 0
  v_mov_b32 v112, 0
  v_mov_b32 v113, 0
  v_mov_b32 v114, 0
  v_mov_b32 v115, 0
  v_mov_b32 v116, 0
  v_mov_b32 v117, 0
  v_mov_b32 v118, 0
  v_mov_b32 v119, 0
  v_mov_b32 v120, 0
  v_mov_b32 v121, 0
  v_mov_b32 v122, 0
  v_mov_b32 v123, 0
  v_mov_b32 v124, 0
  v_mov_b32 v125, 0
  v_mov_b32 v126, 0
  v_mov_b32 v127, 0
  v_mov_b32 v128, 0
  v_mov_b32 v129, 0
  v_mov_b32 v130, 0
  v_mov_b32 v131, 0
  v_mov_b32 v132, 0
  v_mov_b32 v133, 0
  v_mov_b32 v134, 0
  v_mov_b32 v135, 0
  v_mov_b32 v136, 0
  v_mov_b32 v137, 0
  v_mov_b32 v138, 0
  v_mov_b32 v139, 0
  v_mov_b32 v140, 0
  v_mov_b32 v141, 0
  v_mov_b32 v142, 0
  v_mov_b32 v143, 0
  s_mul_i32 s51, s50, 65536
  s_mul_i32 s52, s50, 4096
  s_add_u32 s24, s51, 0
  s_add_u32 s28, s52, 0
  s_add_u32 s25, s51, 262144
  s_add_u32 s29, s52, 16384
  s_add_u32 s26, s51, 524288
  s_add_u32 s30, s52, 32768
  s_add_u32 s27, s51, 786432
  s_add_u32 s31, s52, 49152
  s_lshl_b32 s53, s50, 10
  s_add_u32 m0, s53, 0
  s_nop 0
  buffer_load_dwordx4 v3, s[4:7], s24 offen lds
  s_add_u32 m0, s53, 4096
  s_nop 0
  buffer_load_dwordx4 v3, s[4:7], s25 offen lds
  s_add_u32 m0, s53, 8192
  s_nop 0
  buffer_load_dwordx4 v3, s[4:7], s26 offen lds
  s_add_u32 m0, s53, 12288
  s_nop 0
  buffer_load_dwordx4 v3, s[4:7], s27 offen lds
  s_add_u32 m0, s53, 16384
  s_nop 0
  buffer_load_dwordx4 v4, s[8:11], s28 offen lds
  s_add_u32 m0, s53, 20480
  s_nop 0
  buffer_load_dwordx4 v4, s[8:11], s29 offen lds
  s_add_u32 m0, s53, 24576
  s_nop 0
  buffer_load_dwordx4 v4, s[8:11], s30 offen lds
  s_add_u32 m0, s53, 28672
  s_nop 0
  buffer_load_dwordx4 v4, s[8:11], s31 offen lds
  s_add_u32 s24, s24, 128
  s_add_u32 s28, s28, 65536
  s_add_u32 s25, s25, 128
  s_add_u32 s29, s29, 65536
  s_add_u32 s26, s26, 128
  s_add_u32 s30, s30, 65536
  s_add_u32 s27, s27, 128
  s_add_u32 s31, s31, 65536
  s_add_u32 m0, s53, 32768
  s_nop 0
  buffer_load_dwordx4 v3, s[4:7], s24 offen lds
  s_add_u32 m0, s53, 36864
  s_nop 0
  buffer_load_dwordx4 v3, s[4:7], s25 offen lds
  s_add_u32 m0, s53, 40960
  s_nop 0
  buffer_load_dwordx4 v3, s[4:7], s26 offen lds
  s_add_u32 m0, s53, 45056
  s_nop 0
  buffer_load_dwordx4 v3, s[4:7], s27 offen lds
  s_add_u32 m0, s53, 49152
  s_nop 0
  buffer_load_dwordx4 v4, s[8:11], s28 offen lds
  s_add_u32 m0, s53, 53248
  s_nop 0
  buffer_load_dwordx4 v4, s[8:11], s29 offen lds
  s_add_u32 m0, s53, 57344
  s_nop 0
  buffer_load_dwordx4 v4, s[8:11], s30 offen lds
  s_add_u32 m0, s53, 61440
  s_nop 0
  buffer_load_dwordx4 v4, s[8:11], s31 offen lds
  s_add_u32 s24, s24, 128
  s_add_u32 s28, s28, 65536
  s_add_u32 s25, s25, 128
  s_add_u32 s29, s29, 65536
  s_add_u32 s26, s26, 128
  s_add_u32 s30, s30, 65536
  s_add_u32 s27, s27, 128
  s_add_u32 s31, s31, 65536
  s_add_u32 m0, s53, 65536
  s_nop 0
  buffer_load_dwordx4 v3, s[4:7], s24 offen lds
  s_add_u32 m0, s53, 69632
  s_nop 0
  buffer_load_dwordx4 v3, s[4:7], s25 offen lds
  s_add_u32 m0, s53, 73728
  s_nop 0
  buffer_load_dwordx4 v3, s[4:7], s26 offen lds
  s_add_u32 m0, s53, 77824
  s_nop 0
  buffer_load_dwordx4 v3, s[4:7], s27 offen lds
  s_add_u32 m0, s53, 81920
  s_nop 0
  buffer_load_dwordx4 v4, s[8:11], s28 offen lds
  s_add_u32 m0, s53, 86016
  s_nop 0
  buffer_load_dwordx4 v4, s[8:11], s29 offen lds
  s_add_u32 m0, s53, 90112
  s_nop 0
  buffer_load_dwordx4 v4, s[8:11], s30 offen lds
  s_add_u32 m0, s53, 94208
  s_nop 0
  buffer_load_dwordx4 v4, s[8:11], s31 offen lds
  s_add_u32 s24, s24, 128
  s_add_u32 s28, s28, 65536
  s_add_u32 s25, s25, 128
  s_add_u32 s29, s29, 65536
  s_add_u32 s26, s26, 128
  s_add_u32 s30, s30, 65536
  s_add_u32 s27, s27, 128
  s_add_u32 s31, s31, 65536
  s_mov_b32 s22, 4
L_oproj_kernel_loop:
  s_waitcnt vmcnt(16)
  s_barrier
  s_add_u32 m0, s53, 98304
  s_nop 0
  buffer_load_dwordx4 v3, s[4:7], s24 offen lds
  s_add_u32 m0, s53, 102400
  s_nop 0
  buffer_load_dwordx4 v3, s[4:7], s25 offen lds
  s_add_u32 m0, s53, 106496
  s_nop 0
  buffer_load_dwordx4 v3, s[4:7], s26 offen lds
  s_add_u32 m0, s53, 110592
  s_nop 0
  buffer_load_dwordx4 v3, s[4:7], s27 offen lds
  s_add_u32 m0, s53, 114688
  s_nop 0
  buffer_load_dwordx4 v4, s[8:11], s28 offen lds
  s_add_u32 m0, s53, 118784
  s_nop 0
  buffer_load_dwordx4 v4, s[8:11], s29 offen lds
  s_add_u32 m0, s53, 122880
  s_nop 0
  buffer_load_dwordx4 v4, s[8:11], s30 offen lds
  s_add_u32 m0, s53, 126976
  s_nop 0
  buffer_load_dwordx4 v4, s[8:11], s31 offen lds
  s_add_u32 s24, s24, 128
  s_add_u32 s28, s28, 65536
  s_add_u32 s25, s25, 128
  s_add_u32 s29, s29, 65536
  s_add_u32 s26, s26, 128
  s_add_u32 s30, s30, 65536
  s_add_u32 s27, s27, 128
  s_add_u32 s31, s31, 65536
  ds_read_b128 v[48:51], v12 offset:0
  ds_read_b128 v[52:55], v12 offset:4096
  ds_read_b64_tr_b16 v[56:57], v10 offset:0
  ds_read_b64_tr_b16 v[58:59], v10 offset:1024
  ds_read_b64_tr_b16 v[60:61], v11 offset:0
  ds_read_b64_tr_b16 v[62:63], v11 offset:1024
  ds_read_b128 v[64:67], v13 offset:0
  ds_read_b128 v[68:71], v13 offset:4096
  ds_read_b64_tr_b16 v[72:73], v10 offset:4096
  ds_read_b64_tr_b16 v[74:75], v10 offset:5120
  ds_read_b64_tr_b16 v[76:77], v11 offset:4096
  ds_read_b64_tr_b16 v[78:79], v11 offset:5120
  s_waitcnt lgkmcnt(6)
  v_mfma_f32_32x32x16_bf16 v[80:95], v[56:59], v[48:51], v[80:95]
  v_mfma_f32_32x32x16_bf16 v[96:111], v[56:59], v[52:55], v[96:111]
  v_mfma_f32_32x32x16_bf16 v[112:127], v[60:63], v[48:51], v[112:127]
  v_mfma_f32_32x32x16_bf16 v[128:143], v[60:63], v[52:55], v[128:143]
  ds_read_b128 v[48:51], v14 offset:0
  ds_read_b128 v[52:55], v14 offset:4096
  ds_read_b64_tr_b16 v[56:57], v10 offset:8192
  ds_read_b64_tr_b16 v[58:59], v10 offset:9216
  ds_read_b64_tr_b16 v[60:61], v11 offset:8192
  ds_read_b64_tr_b16 v[62:63], v11 offset:9216
  s_waitcnt lgkmcnt(6)
  v_mfma_f32_32x32x16_bf16 v[80:95], v[72:75], v[64:67], v[80:95]
  v_mfma_f32_32x32x16_bf16 v[96:111], v[72:75], v[68:71], v[96:111]
  v_mfma_f32_32x32x16_bf16 v[112:127], v[76:79], v[64:67], v[112:127]
  v_mfma_f32_32x32x16_bf16 v[128:143], v[76:79], v[68:71], v[128:143]
  ds_read_b128 v[64:67], v15 offset:0
  ds_read_b128 v[68:71], v15 offset:4096
  ds_read_b64_tr_b16 v[72:73], v10 offset:12288
  ds_read_b64_tr_b16 v[74:75], v10 offset:13312
  ds_read_b64_tr_b16 v[76:77], v11 offset:12288
  ds_read_b64_tr_b16 v[78:79], v11 offset:13312
  s_waitcnt lgkmcnt(6)
  v_mfma_f32_32x32x16_bf16 v[80:95], v[56:59], v[48:51], v[80:95]
  v_mfma_f32_32x32x16_bf16 v[96:111], v[56:59], v[52:55], v[96:111]
  v_mfma_f32_32x32x16_bf16 v[112:127], v[60:63], v[48:51], v[112:127]
  v_mfma_f32_32x32x16_bf16 v[128:143], v[60:63], v[52:55], v[128:143]
  s_waitcnt lgkmcnt(0)
  v_mfma_f32_32x32x16_bf16 v[80:95], v[72:75], v[64:67], v[80:95]
  v_mfma_f32_32x32x16_bf16 v[96:111], v[72:75], v[68:71], v[96:111]
  v_mfma_f32_32x32x16_bf16 v[112:127], v[76:79], v[64:67], v[112:127]
  v_mfma_f32_32x32x16_bf16 v[128:143], v[76:79], v[68:71], v[128:143]
  s_waitcnt vmcnt(16)
  s_barrier
  s_add_u32 m0, s53, 0
  s_nop 0
  buffer_load_dwordx4 v3, s[4:7], s24 offen lds
  s_add_u32 m0, s53, 4096
  s_nop 0
  buffer_load_dwordx4 v3, s[4:7], s25 offen lds
  s_add_u32 m0, s53, 8192
  s_nop 0
  buffer_load_dwordx4 v3, s[4:7], s26 offen lds
  s_add_u32 m0, s53, 12288
  s_nop 0
  buffer_load_dwordx4 v3, s[4:7], s27 offen lds
  s_add_u32 m0, s53, 16384
  s_nop 0
  buffer_load_dwordx4 v4, s[8:11], s28 offen lds
  s_add_u32 m0, s53, 20480
  s_nop 0
  buffer_load_dwordx4 v4, s[8:11], s29 offen lds
  s_add_u32 m0, s53, 24576
  s_nop 0
  buffer_load_dwordx4 v4, s[8:11], s30 offen lds
  s_add_u32 m0, s53, 28672
  s_nop 0
  buffer_load_dwordx4 v4, s[8:11], s31 offen lds
  s_add_u32 s24, s24, 128
  s_add_u32 s28, s28, 65536
  s_add_u32 s25, s25, 128
  s_add_u32 s29, s29, 65536
  s_add_u32 s26, s26, 128
  s_add_u32 s30, s30, 65536
  s_add_u32 s27, s27, 128
  s_add_u32 s31, s31, 65536
  ds_read_b128 v[48:51], v12 offset:32768
  ds_read_b128 v[52:55], v12 offset:36864
  ds_read_b64_tr_b16 v[56:57], v10 offset:32768
  ds_read_b64_tr_b16 v[58:59], v10 offset:33792
  ds_read_b64_tr_b16 v[60:61], v11 offset:32768
  ds_read_b64_tr_b16 v[62:63], v11 offset:33792
  ds_read_b128 v[64:67], v13 offset:32768
  ds_read_b128 v[68:71], v13 offset:36864
  ds_read_b64_tr_b16 v[72:73], v10 offset:36864
  ds_read_b64_tr_b16 v[74:75], v10 offset:37888
  ds_read_b64_tr_b16 v[76:77], v11 offset:36864
  ds_read_b64_tr_b16 v[78:79], v11 offset:37888
  s_waitcnt lgkmcnt(6)
  v_mfma_f32_32x32x16_bf16 v[80:95], v[56:59], v[48:51], v[80:95]
  v_mfma_f32_32x32x16_bf16 v[96:111], v[56:59], v[52:55], v[96:111]
  v_mfma_f32_32x32x16_bf16 v[112:127], v[60:63], v[48:51], v[112:127]
  v_mfma_f32_32x32x16_bf16 v[128:143], v[60:63], v[52:55], v[128:143]
  ds_read_b128 v[48:51], v14 offset:32768
  ds_read_b128 v[52:55], v14 offset:36864
  ds_read_b64_tr_b16 v[56:57], v10 offset:40960
  ds_read_b64_tr_b16 v[58:59], v10 offset:41984
  ds_read_b64_tr_b16 v[60:61], v11 offset:40960
  ds_read_b64_tr_b16 v[62:63], v11 offset:41984
  s_waitcnt lgkmcnt(6)
  v_mfma_f32_32x32x16_bf16 v[80:95], v[72:75], v[64:67], v[80:95]
  v_mfma_f32_32x32x16_bf16 v[96:111], v[72:75], v[68:71], v[96:111]
  v_mfma_f32_32x32x16_bf16 v[112:127], v[76:79], v[64:67], v[112:127]
  v_mfma_f32_32x32x16_bf16 v[128:143], v[76:79], v[68:71], v[128:143]
  ds_read_b128 v[64:67], v15 offset:32768
  ds_read_b128 v[68:71], v15 offset:36864
  ds_read_b64_tr_b16 v[72:73], v10 offset:45056
  ds_read_b64_tr_b16 v[74:75], v10 offset:46080
  ds_read_b64_tr_b16 v[76:77], v11 offset:45056
  ds_read_b64_tr_b16 v[78:79], v11 offset:46080
  s_waitcnt lgkmcnt(6)
  v_mfma_f32_32x32x16_bf16 v[80:95], v[56:59], v[48:51], v[80:95]
  v_mfma_f32_32x32x16_bf16 v[96:111], v[56:59], v[52:55], v[96:111]
  v_mfma_f32_32x32x16_bf16 v[112:127], v[60:63], v[48:51], v[112:127]
  v_mfma_f32_32x32x16_bf16 v[128:143], v[60:63], v[52:55], v[128:143]
  s_waitcnt lgkmcnt(0)
  v_mfma_f32_32x32x16_bf16 v[80:95], v[72:75], v[64:67], v[80:95]
  v_mfma_f32_32x32x16_bf16 v[96:111], v[72:75], v[68:71], v[96:111]
  v_mfma_f32_32x32x16_bf16 v[112:127], v[76:79], v[64:67], v[112:127]
  v_mfma_f32_32x32x16_bf16 v[128:143], v[76:79], v[68:71], v[128:143]
  s_waitcnt vmcnt(16)
  s_barrier
  s_add_u32 m0, s53, 32768
  s_nop 0
  buffer_load_dwordx4 v3, s[4:7], s24 offen lds
  s_add_u32 m0, s53, 36864
  s_nop 0
  buffer_load_dwordx4 v3, s[4:7], s25 offen lds
  s_add_u32 m0, s53, 40960
  s_nop 0
  buffer_load_dwordx4 v3, s[4:7], s26 offen lds
  s_add_u32 m0, s53, 45056
  s_nop 0
  buffer_load_dwordx4 v3, s[4:7], s27 offen lds
  s_add_u32 m0, s53, 49152
  s_nop 0
  buffer_load_dwordx4 v4, s[8:11], s28 offen lds
  s_add_u32 m0, s53, 53248
  s_nop 0
  buffer_load_dwordx4 v4, s[8:11], s29 offen lds
  s_add_u32 m0, s53, 57344
  s_nop 0
  buffer_load_dwordx4 v4, s[8:11], s30 offen lds
  s_add_u32 m0, s53, 61440
  s_nop 0
  buffer_load_dwordx4 v4, s[8:11], s31 offen lds
  s_add_u32 s24, s24, 128
  s_add_u32 s28, s28, 65536
  s_add_u32 s25, s25, 128
  s_add_u32 s29, s29, 65536
  s_add_u32 s26, s26, 128
  s_add_u32 s30, s30, 65536
  s_add_u32 s27, s27, 128
  s_add_u32 s31, s31, 65536
  ds_read_b128 v[48:51], v144 offset:0
  ds_read_b128 v[52:55], v144 offset:4096
  ds_read_b64_tr_b16 v[56:57], v148 offset:0
  ds_read_b64_tr_b16 v[58:59], v148 offset:1024
  ds_read_b64_tr_b16 v[60:61], v149 offset:0
  ds_read_b64_tr_b16 v[62:63], v149 offset:1024
  ds_read_b128 v[64:67], v145 offset:0
  ds_read_b128 v[68:71], v145 offset:4096
  ds_read_b64_tr_b16 v[72:73], v148 offset:4096
  ds_read_b64_tr_b16 v[74:75], v148 offset:5120
  ds_read_b64_tr_b16 v[76:77], v149 offset:4096
  ds_read_b64_tr_b16 v[78:79], v149 offset:5120
  s_waitcnt lgkmcnt(6)
  v_mfma_f32_32x32x16_bf16 v[80:95], v[56:59], v[48:51], v[80:95]
  v_mfma_f32_32x32x16_bf16 v[96:111], v[56:59], v[52:55], v[96:111]
  v_mfma_f32_32x32x16_bf16 v[112:127], v[60:63], v[48:51], v[112:127]
  v_mfma_f32_32x32x16_bf16 v[128:143], v[60:63], v[52:55], v[128:143]
  ds_read_b128 v[48:51], v146 offset:0
  ds_read_b128 v[52:55], v146 offset:4096
  ds_read_b64_tr_b16 v[56:57], v148 offset:8192
  ds_read_b64_tr_b16 v[58:59], v148 offset:9216
  ds_read_b64_tr_b16 v[60:61], v149 offset:8192
  ds_read_b64_tr_b16 v[62:63], v149 offset:9216
  s_waitcnt lgkmcnt(6)
  v_mfma_f32_32x32x16_bf16 v[80:95], v[72:75], v[64:67], v[80:95]
  v_mfma_f32_32x32x16_bf16 v[96:111], v[72:75], v[68:71], v[96:111]
  v_mfma_f32_32x32x16_bf16 v[112:127], v[76:79], v[64:67], v[112:127]
  v_mfma_f32_32x32x16_bf16 v[128:143], v[76:79], v[68:71], v[128:143]
  ds_read_b128 v[64:67], v147 offset:0
  ds_read_b128 v[68:71], v147 offset:4096
  ds_read_b64_tr_b16 v[72:73], v148 offset:12288
  ds_read_b64_tr_b16 v[74:75], v148 offset:13312
  ds_read_b64_tr_b16 v[76:77], v149 offset:12288
  ds_read_b64_tr_b16 v[78:79], v149 offset:13312
  s_waitcnt lgkmcnt(6)
  v_mfma_f32_32x32x16_bf16 v[80:95], v[56:59], v[48:51], v[80:95]
  v_mfma_f32_32x32x16_bf16 v[96:111], v[56:59], v[52:55], v[96:111]
  v_mfma_f32_32x32x16_bf16 v[112:127], v[60:63], v[48:51], v[112:127]
  v_mfma_f32_32x32x16_bf16 v[128:143], v[60:63], v[52:55], v[128:143]
  s_waitcnt lgkmcnt(0)
  v_mfma_f32_32x32x16_bf16 v[80:95], v[72:75], v[64:67], v[80:95]
  v_mfma_f32_32x32x16_bf16 v[96:111], v[72:75], v[68:71], v[96:111]
  v_mfma_f32_32x32x16_bf16 v[112:127], v[76:79], v[64:67], v[112:127]
  v_mfma_f32_32x32x16_bf16 v[128:143], v[76:79], v[68:71], v[128:143]
  s_waitcnt vmcnt(16)
  s_barrier
  s_add_u32 m0, s53, 65536
  s_nop 0
  buffer_load_dwordx4 v3, s[4:7], s24 offen lds
  s_add_u32 m0, s53, 69632
  s_nop 0
  buffer_load_dwordx4 v3, s[4:7], s25 offen lds
  s_add_u32 m0, s53, 73728
  s_nop 0
  buffer_load_dwordx4 v3, s[4:7], s26 offen lds
  s_add_u32 m0, s53, 77824
  s_nop 0
  buffer_load_dwordx4 v3, s[4:7], s27 offen lds
  s_add_u32 m0, s53, 81920
  s_nop 0
  buffer_load_dwordx4 v4, s[8:11], s28 offen lds
  s_add_u32 m0, s53, 86016
  s_nop 0
  buffer_load_dwordx4 v4, s[8:11], s29 offen lds
  s_add_u32 m0, s53, 90112
  s_nop 0
  buffer_load_dwordx4 v4, s[8:11], s30 offen lds
  s_add_u32 m0, s53, 94208
  s_nop 0
  buffer_load_dwordx4 v4, s[8:11], s31 offen lds
  s_add_u32 s24, s24, 128
  s_add_u32 s28, s28, 65536
  s_add_u32 s25, s25, 128
  s_add_u32 s29, s29, 65536
  s_add_u32 s26, s26, 128
  s_add_u32 s30, s30, 65536
  s_add_u32 s27, s27, 128
  s_add_u32 s31, s31, 65536
  ds_read_b128 v[48:51], v144 offset:32768
  ds_read_b128 v[52:55], v144 offset:36864
  ds_read_b64_tr_b16 v[56:57], v148 offset:32768
  ds_read_b64_tr_b16 v[58:59], v148 offset:33792
  ds_read_b64_tr_b16 v[60:61], v149 offset:32768
  ds_read_b64_tr_b16 v[62:63], v149 offset:33792
  ds_read_b128 v[64:67], v145 offset:32768
  ds_read_b128 v[68:71], v145 offset:36864
  ds_read_b64_tr_b16 v[72:73], v148 offset:36864
  ds_read_b64_tr_b16 v[74:75], v148 offset:37888
  ds_read_b64_tr_b16 v[76:77], v149 offset:36864
  ds_read_b64_tr_b16 v[78:79], v149 offset:37888
  s_waitcnt lgkmcnt(6)
  v_mfma_f32_32x32x16_bf16 v[80:95], v[56:59], v[48:51], v[80:95]
  v_mfma_f32_32x32x16_bf16 v[96:111], v[56:59], v[52:55], v[96:111]
  v_mfma_f32_32x32x16_bf16 v[112:127], v[60:63], v[48:51], v[112:127]
  v_mfma_f32_32x32x16_bf16 v[128:143], v[60:63], v[52:55], v[128:143]
  ds_read_b128 v[48:51], v146 offset:32768
  ds_read_b128 v[52:55], v146 offset:36864
  ds_read_b64_tr_b16 v[56:57], v148 offset:40960
  ds_read_b64_tr_b16 v[58:59], v148 offset:41984
  ds_read_b64_tr_b16 v[60:61], v149 offset:40960
  ds_read_b64_tr_b16 v[62:63], v149 offset:41984
  s_waitcnt lgkmcnt(6)
  v_mfma_f32_32x32x16_bf16 v[80:95], v[72:75], v[64:67], v[80:95]
  v_mfma_f32_32x32x16_bf16 v[96:111], v[72:75], v[68:71], v[96:111]
  v_mfma_f32_32x32x16_bf16 v[112:127], v[76:79], v[64:67], v[112:127]
  v_mfma_f32_32x32x16_bf16 v[128:143], v[76:79], v[68:71], v[128:143]
  ds_read_b128 v[64:67], v147 offset:32768
  ds_read_b128 v[68:71], v147 offset:36864
  ds_read_b64_tr_b16 v[72:73], v148 offset:45056
  ds_read_b64_tr_b16 v[74:75], v148 offset:46080
  ds_read_b64_tr_b16 v[76:77], v149 offset:45056
  ds_read_b64_tr_b16 v[78:79], v149 offset:46080
  s_waitcnt lgkmcnt(6)
  v_mfma_f32_32x32x16_bf16 v[80:95], v[56:59], v[48:51], v[80:95]
  v_mfma_f32_32x32x16_bf16 v[96:111], v[56:59], v[52:55], v[96:111]
  v_mfma_f32_32x32x16_bf16 v[112:127], v[60:63], v[48:51], v[112:127]
  v_mfma_f32_32x32x16_bf16 v[128:143], v[60:63], v[52:55], v[128:143]
  s_waitcnt lgkmcnt(0)
  v_mfma_f32_32x32x16_bf16 v[80:95], v[72:75], v[64:67], v[80:95]
  v_mfma_f32_32x32x16_bf16 v[96:111], v[72:75], v[68:71], v[96:111]
  v_mfma_f32_32x32x16_bf16 v[112:127], v[76:79], v[64:67], v[112:127]
  v_mfma_f32_32x32x16_bf16 v[128:143], v[76:79], v[68:71], v[128:143]
  s_sub_u32 s22, s22, 1
  s_cmp_lg_u32 s22, 0
  s_cbranch_scc1 L_oproj_kernel_loop
  s_waitcnt vmcnt(0)
  s_barrier
  s_nop 7
  s_nop 7
  v_and_b32 v9, 63, v0
  v_and_b32 v1, 31, v9
  v_lshrrev_b32 v2, 5, v9
  v_lshrrev_b32 v8, 6, v0
  v_lshrrev_b32 v7, 1, v8
  v_and_b32 v8, 1, v8

  v_lshl_add_u32 v3, v7, 6, v1
  v_mul_u32_u24 v3, 2048, v3
  v_lshlrev_b32 v4, 4, v2
  v_lshl_add_u32 v4, v8, 8, v4
  v_add_u32 v3, v3, v4
  s_mov_b32 s23, 65536

  buffer_store_dwordx4 v[80:83], v3, s[12:15], 0 offen offset:0
  buffer_store_dwordx4 v[84:87], v3, s[12:15], 0 offen offset:32
  buffer_store_dwordx4 v[88:91], v3, s[12:15], 0 offen offset:64
  buffer_store_dwordx4 v[92:95], v3, s[12:15], 0 offen offset:96
  buffer_store_dwordx4 v[96:99], v3, s[12:15], s23 offen offset:0
  buffer_store_dwordx4 v[100:103], v3, s[12:15], s23 offen offset:32
  buffer_store_dwordx4 v[104:107], v3, s[12:15], s23 offen offset:64
  buffer_store_dwordx4 v[108:111], v3, s[12:15], s23 offen offset:96
  buffer_store_dwordx4 v[112:115], v3, s[12:15], 0 offen offset:128
  buffer_store_dwordx4 v[116:119], v3, s[12:15], 0 offen offset:160
  buffer_store_dwordx4 v[120:123], v3, s[12:15], 0 offen offset:192
  buffer_store_dwordx4 v[124:127], v3, s[12:15], 0 offen offset:224
  buffer_store_dwordx4 v[128:131], v3, s[12:15], s23 offen offset:128
  buffer_store_dwordx4 v[132:135], v3, s[12:15], s23 offen offset:160
  buffer_store_dwordx4 v[136:139], v3, s[12:15], s23 offen offset:192
  buffer_store_dwordx4 v[140:143], v3, s[12:15], s23 offen offset:224
L_oproj_kernel_done:
  s_endpgm
.section .rodata,"a"
.p2align 6
.amdhsa_kernel oproj_kernel
  .amdhsa_next_free_vgpr 152
  .amdhsa_next_free_sgpr 96
  .amdhsa_accum_offset 152
  .amdhsa_group_segment_fixed_size 0
  .amdhsa_kernarg_size 112
  .amdhsa_user_sgpr_count 2
  .amdhsa_user_sgpr_kernarg_segment_ptr 1
  .amdhsa_system_sgpr_workgroup_id_x 1
.end_amdhsa_kernel
.text
.globl ln2_kernel
.p2align 8
.type ln2_kernel,@function
ln2_kernel:
  s_cmp_ge_u32 s2, 512
  s_cbranch_scc1 L_ln2_kernel_done
  s_load_dwordx2 s[4:5], s[0:1], 0
  s_load_dwordx2 s[6:7], s[0:1], 104
  v_lshrrev_b32 v1, 6, v0
  v_and_b32 v2, 63, v0
  s_lshl_b32 s3, s2, 2
  v_add_u32 v1, s3, v1
  v_lshlrev_b32 v3, 10, v1
  v_lshl_add_u32 v3, v2, 4, v3
  s_waitcnt lgkmcnt(0)
  s_mov_b32 s8, s4
  s_and_b32 s9, s5, 0xffff
  s_mov_b32 s10, 2097152
  s_mov_b32 s11, 0x00020000
  s_add_u32 s20, s6, 88080384
  s_addc_u32 s21, s7, 0
  s_mov_b32 s12, s20
  s_and_b32 s13, s21, 0xffff
  s_mov_b32 s14, 2097152
  s_mov_b32 s15, 0x00020000
  s_add_u32 s20, s6, 85983232
  s_addc_u32 s21, s7, 0
  s_mov_b32 s16, s20
  s_and_b32 s17, s21, 0xffff
  s_mov_b32 s18, 2097152
  s_mov_b32 s19, 0x00020000
  s_add_u32 s20, s6, 69206016
  s_addc_u32 s21, s7, 0
  s_mov_b32 s24, s20
  s_and_b32 s25, s21, 0xffff
  s_mov_b32 s26, 16777216
  s_mov_b32 s27, 0x00020000
  buffer_load_dwordx4 v[4:7], v3, s[8:11], 0 offen
  v_lshlrev_b32 v8, 11, v1
  v_lshl_add_u32 v8, v2, 5, v8
  s_mov_b32 s28, 0
  buffer_load_dwordx4 v[40:43], v8, s[24:27], s28 offen
  buffer_load_dwordx4 v[44:47], v8, s[24:27], s28 offen offset:16
  s_mov_b32 s28, 4194304
  buffer_load_dwordx4 v[48:51], v8, s[24:27], s28 offen
  buffer_load_dwordx4 v[52:55], v8, s[24:27], s28 offen offset:16
  s_mov_b32 s28, 8388608
  buffer_load_dwordx4 v[56:59], v8, s[24:27], s28 offen
  buffer_load_dwordx4 v[60:63], v8, s[24:27], s28 offen offset:16
  s_mov_b32 s28, 12582912
  buffer_load_dwordx4 v[64:67], v8, s[24:27], s28 offen
  buffer_load_dwordx4 v[68:71], v8, s[24:27], s28 offen offset:16
  s_waitcnt vmcnt(0)
  v_lshlrev_b32 v10, 16, v4
  v_and_b32 v11, 0xffff0000, v4
  v_lshlrev_b32 v12, 16, v5
  v_and_b32 v13, 0xffff0000, v5
  v_lshlrev_b32 v14, 16, v6
  v_and_b32 v15, 0xffff0000, v6
  v_lshlrev_b32 v16, 16, v7
  v_and_b32 v17, 0xffff0000, v7
  v_add_f32 v40, v40, v48
  v_add_f32 v56, v56, v64
  v_add_f32 v41, v41, v49
  v_add_f32 v57, v57, v65
  v_add_f32 v42, v42, v50
  v_add_f32 v58, v58, v66
  v_add_f32 v43, v43, v51
  v_add_f32 v59, v59, v67
  v_add_f32 v44, v44, v52
  v_add_f32 v60, v60, v68
  v_add_f32 v45, v45, v53
  v_add_f32 v61, v61, v69
  v_add_f32 v46, v46, v54
  v_add_f32 v62, v62, v70
  v_add_f32 v47, v47, v55
  v_add_f32 v63, v63, v71
  v_add_f32 v40, v40, v56
  v_add_f32 v41, v41, v57
  v_add_f32 v42, v42, v58
  v_add_f32 v43, v43, v59
  v_add_f32 v44, v44, v60
  v_add_f32 v45, v45, v61
  v_add_f32 v46, v46, v62
  v_add_f32 v47, v47, v63
  v_cvt_pk_bf16_f32 v48, v40, v41
  v_cvt_pk_bf16_f32 v49, v42, v43
  v_cvt_pk_bf16_f32 v50, v44, v45
  v_cvt_pk_bf16_f32 v51, v46, v47
  v_lshlrev_b32 v40, 16, v48
  v_and_b32 v41, 0xffff0000, v48
  v_lshlrev_b32 v42, 16, v49
  v_and_b32 v43, 0xffff0000, v49
  v_lshlrev_b32 v44, 16, v50
  v_and_b32 v45, 0xffff0000, v50
  v_lshlrev_b32 v46, 16, v51
  v_and_b32 v47, 0xffff0000, v51
  v_add_f32 v10, v10, v40
  v_add_f32 v11, v11, v41
  v_add_f32 v12, v12, v42
  v_add_f32 v13, v13, v43
  v_add_f32 v14, v14, v44
  v_add_f32 v15, v15, v45
  v_add_f32 v16, v16, v46
  v_add_f32 v17, v17, v47
  v_cvt_pk_bf16_f32 v4, v10, v11
  v_cvt_pk_bf16_f32 v5, v12, v13
  v_cvt_pk_bf16_f32 v6, v14, v15
  v_cvt_pk_bf16_f32 v7, v16, v17
  v_lshlrev_b32 v10, 16, v4
  v_and_b32 v11, 0xffff0000, v4
  v_lshlrev_b32 v12, 16, v5
  v_and_b32 v13, 0xffff0000, v5
  v_lshlrev_b32 v14, 16, v6
  v_and_b32 v15, 0xffff0000, v6
  v_lshlrev_b32 v16, 16, v7
  v_and_b32 v17, 0xffff0000, v7
  buffer_store_dwordx4 v[4:7], v3, s[16:19], 0 offen
  v_add_f32 v20, v10, v11
  v_add_f32 v20, v20, v12
  v_add_f32 v20, v20, v13
  v_add_f32 v20, v20, v14
  v_add_f32 v20, v20, v15
  v_add_f32 v20, v20, v16
  v_add_f32 v20, v20, v17
  ds_swizzle_b32 v21, v20 offset:0x41f
  s_waitcnt lgkmcnt(0)
  v_add_f32 v20, v20, v21
  ds_swizzle_b32 v21, v20 offset:0x81f
  s_waitcnt lgkmcnt(0)
  v_add_f32 v20, v20, v21
  ds_swizzle_b32 v21, v20 offset:0x101f
  s_waitcnt lgkmcnt(0)
  v_add_f32 v20, v20, v21
  ds_swizzle_b32 v21, v20 offset:0x201f
  s_waitcnt lgkmcnt(0)
  v_add_f32 v20, v20, v21
  ds_swizzle_b32 v21, v20 offset:0x401f
  s_waitcnt lgkmcnt(0)
  v_add_f32 v20, v20, v21
  v_mov_b32 v21, v20
  s_nop 1
  v_permlane32_swap_b32 v21, v20
  s_nop 1
  v_add_f32 v20, v20, v21
  v_mul_f32 v20, 0x3b000000, v20
  v_sub_f32 v24, v10, v20
  v_sub_f32 v25, v11, v20
  v_sub_f32 v26, v12, v20
  v_sub_f32 v27, v13, v20
  v_sub_f32 v28, v14, v20
  v_sub_f32 v29, v15, v20
  v_sub_f32 v30, v16, v20
  v_sub_f32 v31, v17, v20
  v_mul_f32 v22, v24, v24
  v_fmac_f32 v22, v25, v25
  v_fmac_f32 v22, v26, v26
  v_fmac_f32 v22, v27, v27
  v_fmac_f32 v22, v28, v28
  v_fmac_f32 v22, v29, v29
  v_fmac_f32 v22, v30, v30
  v_fmac_f32 v22, v31, v31
  ds_swizzle_b32 v21, v22 offset:0x41f
  s_waitcnt lgkmcnt(0)
  v_add_f32 v22, v22, v21
  ds_swizzle_b32 v21, v22 offset:0x81f
  s_waitcnt lgkmcnt(0)
  v_add_f32 v22, v22, v21
  ds_swizzle_b32 v21, v22 offset:0x101f
  s_waitcnt lgkmcnt(0)
  v_add_f32 v22, v22, v21
  ds_swizzle_b32 v21, v22 offset:0x201f
  s_waitcnt lgkmcnt(0)
  v_add_f32 v22, v22, v21
  ds_swizzle_b32 v21, v22 offset:0x401f
  s_waitcnt lgkmcnt(0)
  v_add_f32 v22, v22, v21
  v_mov_b32 v21, v22
  s_nop 1
  v_permlane32_swap_b32 v21, v22
  s_nop 1
  v_add_f32 v22, v22, v21
  v_mul_f32 v22, 0x3b000000, v22
  v_cvt_pk_bf16_f32 v23, v20, v22
  v_lshlrev_b32 v20, 16, v23
  v_and_b32 v22, 0xffff0000, v23
  v_add_f32 v22, 0x3727c5ac, v22
  v_cvt_pk_bf16_f32 v22, v22, v22
  v_lshlrev_b32 v22, 16, v22
  v_sqrt_f32 v22, v22
  s_nop 1
  v_cvt_pk_bf16_f32 v22, v22, v22
  v_lshlrev_b32 v22, 16, v22
  v_rcp_f32 v23, v22
  s_nop 1
  v_sub_f32 v24, v10, v20
  v_sub_f32 v25, v11, v20
  v_sub_f32 v26, v12, v20
  v_sub_f32 v27, v13, v20
  v_sub_f32 v28, v14, v20
  v_sub_f32 v29, v15, v20
  v_sub_f32 v30, v16, v20
  v_sub_f32 v31, v17, v20
  v_cvt_pk_bf16_f32 v32, v24, v25
  v_cvt_pk_bf16_f32 v33, v26, v27
  v_cvt_pk_bf16_f32 v34, v28, v29
  v_cvt_pk_bf16_f32 v35, v30, v31
  v_lshlrev_b32 v24, 16, v32
  v_and_b32 v25, 0xffff0000, v32
  v_lshlrev_b32 v26, 16, v33
  v_and_b32 v27, 0xffff0000, v33
  v_lshlrev_b32 v28, 16, v34
  v_and_b32 v29, 0xffff0000, v34
  v_lshlrev_b32 v30, 16, v35
  v_and_b32 v31, 0xffff0000, v35
  v_mul_f32 v32, v24, v23
  v_mul_f32 v33, v25, v23
  v_mul_f32 v34, v26, v23
  v_mul_f32 v35, v27, v23
  v_mul_f32 v36, v28, v23
  v_mul_f32 v37, v29, v23
  v_mul_f32 v38, v30, v23
  v_mul_f32 v39, v31, v23
  v_fma_f32 v10, -v32, v22, v24
  v_fma_f32 v11, -v33, v22, v25
  v_fma_f32 v12, -v34, v22, v26
  v_fma_f32 v13, -v35, v22, v27
  v_fma_f32 v14, -v36, v22, v28
  v_fma_f32 v15, -v37, v22, v29
  v_fma_f32 v16, -v38, v22, v30
  v_fma_f32 v17, -v39, v22, v31
  v_fmac_f32 v32, v10, v23
  v_fmac_f32 v33, v11, v23
  v_fmac_f32 v34, v12, v23
  v_fmac_f32 v35, v13, v23
  v_fmac_f32 v36, v14, v23
  v_fmac_f32 v37, v15, v23
  v_fmac_f32 v38, v16, v23
  v_fmac_f32 v39, v17, v23
  v_cvt_pk_bf16_f32 v4, v32, v33
  v_cvt_pk_bf16_f32 v5, v34, v35
  v_cvt_pk_bf16_f32 v6, v36, v37
  v_cvt_pk_bf16_f32 v7, v38, v39
  buffer_store_dwordx4 v[4:7], v3, s[12:15], 0 offen
L_ln2_kernel_done:
  s_endpgm
.section .rodata,"a"
.p2align 6
.amdhsa_kernel ln2_kernel
  .amdhsa_next_free_vgpr 72
  .amdhsa_next_free_sgpr 96
  .amdhsa_accum_offset 72
  .amdhsa_group_segment_fixed_size 0
  .amdhsa_kernarg_size 112
  .amdhsa_user_sgpr_count 2
  .amdhsa_user_sgpr_kernarg_segment_ptr 1
  .amdhsa_system_sgpr_workgroup_id_x 1
.end_amdhsa_kernel
.text
.globl ffn1_kernel
.p2align 8
.type ffn1_kernel,@function
ffn1_kernel:
  s_cmp_ge_u32 s2, 176
  s_cbranch_scc1 L_ffn1_kernel_done
  s_load_dwordx4 s[32:35], s[0:1], 56
  s_load_dwordx2 s[40:41], s[0:1], 104
  s_and_b32 s17, s2, 15
  s_lshr_b32 s16, s2, 4
  s_waitcnt lgkmcnt(0)
  s_add_u32 s44, s40, 88080384
  s_addc_u32 s45, s41, 0
  s_lshl_b32 s19, s17, 17
  s_add_u32 s44, s44, s19
  s_addc_u32 s45, s45, 0

  s_mov_b32 s4, s44
  s_and_b32 s5, s45, 0xffff
  s_mov_b32 s6, 131072
  s_mov_b32 s7, 0x00020000
  s_lshl_b32 s19, s16, 8
  s_add_u32 s46, s32, s19
  s_addc_u32 s47, s33, 0
  s_sub_u32 s20, 1409024, s19

  s_mov_b32 s8, s46
  s_and_b32 s9, s47, 0xffff
  s_mov_b32 s10, s20
  s_mov_b32 s11, 0x00020000
  s_add_u32 s46, s34, s19
  s_addc_u32 s47, s35, 0
  s_sub_u32 s20, 2752, s19

  s_mov_b32 s56, s46
  s_and_b32 s57, s47, 0xffff
  s_mov_b32 s58, s20
  s_mov_b32 s59, 0x00020000
  s_mul_i32 s20, s17, 360448
  s_add_u32 s20, s20, 90177536
  s_add_u32 s20, s20, s19
  s_add_u32 s44, s40, s20
  s_addc_u32 s45, s41, 0

  s_mov_b32 s12, s44
  s_and_b32 s13, s45, 0xffff
  s_mov_b32 s14, 360448
  s_mov_b32 s15, 0x00020000
  v_and_b32 v1, 63, v0
  v_lshrrev_b32 v2, 6, v0
  s_nop 1
  v_readfirstlane_b32 s50, v2
  v_lshrrev_b32 v5, 3, v1
  v_and_b32 v6, 7, v1
  v_lshrrev_b32 v7, 4, v1
  v_and_b32 v8, 1, v2
  v_lshl_add_u32 v8, v8, 2, v7
  v_xor_b32 v6, v6, v8
  v_mul_u32_u24 v3, 1024, v5
  v_lshl_add_u32 v3, v6, 4, v3
  v_and_b32 v6, 15, v1
  v_lshlrev_b32 v8, 2, v7
  v_xor_b32 v6, v6, v8
  v_mul_u32_u24 v4, 2752, v7
  v_lshl_add_u32 v4, v6, 4, v4

  v_and_b32 v1, 63, v0
  v_lshrrev_b32 v2, 6, v0
  v_lshrrev_b32 v7, 1, v2
  v_and_b32 v2, 1, v2
  v_and_b32 v8, 31, v1
  v_lshl_add_u32 v8, v7, 6, v8
  v_lshlrev_b32 v8, 7, v8
  v_lshrrev_b32 v9, 1, v1
  v_and_b32 v9, 7, v9
  v_lshrrev_b32 v10, 5, v1

  v_add_u32 v11, 0, v10
  v_xor_b32 v11, v11, v9
  v_lshl_add_u32 v12, v11, 4, v8

  v_add_u32 v11, 2, v10
  v_xor_b32 v11, v11, v9
  v_lshl_add_u32 v13, v11, 4, v8

  v_add_u32 v11, 4, v10
  v_xor_b32 v11, v11, v9
  v_lshl_add_u32 v14, v11, 4, v8

  v_add_u32 v11, 6, v10
  v_xor_b32 v11, v11, v9
  v_lshl_add_u32 v15, v11, 4, v8

  v_and_b32 v8, 15, v1
  v_lshrrev_b32 v9, 2, v8
  v_and_b32 v8, 3, v8
  v_lshrrev_b32 v7, 4, v1
  v_lshrrev_b32 v10, 1, v7
  v_lshlrev_b32 v10, 3, v10
  v_add_u32 v10, v10, v9
  v_lshlrev_b32 v10, 8, v10
  v_and_b32 v7, 1, v7
  v_lshlrev_b32 v7, 1, v7
  v_lshrrev_b32 v11, 1, v8
  v_add_u32 v7, v7, v11
  v_lshl_add_u32 v7, v2, 3, v7
  v_lshlrev_b32 v9, 2, v9
  v_and_b32 v8, 1, v8
  v_lshlrev_b32 v8, 3, v8
  v_add_u32 v10, v10, v8
  v_add_u32 v10, 16384, v10
  v_xor_b32 v11, v7, v9
  v_lshl_add_u32 v1, v11, 4, v10
  v_add_u32 v7, 4, v7
  v_xor_b32 v11, v7, v9
  v_lshl_add_u32 v2, v11, 4, v10
  v_mov_b32 v10, v1
  v_mov_b32 v11, v2

  v_add_u32 v144, 0x10000, v12
  v_add_u32 v145, 0x10000, v13
  v_add_u32 v146, 0x10000, v14
  v_add_u32 v147, 0x10000, v15
  v_add_u32 v148, 0x10000, v10
  v_add_u32 v149, 0x10000, v11
  v_mov_b32 v80, 0
  v_mov_b32 v81, 0
  v_mov_b32 v82, 0
  v_mov_b32 v83, 0
  v_mov_b32 v84, 0
  v_mov_b32 v85, 0
  v_mov_b32 v86, 0
  v_mov_b32 v87, 0
  v_mov_b32 v88, 0
  v_mov_b32 v89, 0
  v_mov_b32 v90, 0
  v_mov_b32 v91, 0
  v_mov_b32 v92, 0
  v_mov_b32 v93, 0
  v_mov_b32 v94, 0
  v_mov_b32 v95, 0
  v_mov_b32 v96, 0
  v_mov_b32 v97, 0
  v_mov_b32 v98, 0
  v_mov_b32 v99, 0
  v_mov_b32 v100, 0
  v_mov_b32 v101, 0
  v_mov_b32 v102, 0
  v_mov_b32 v103, 0
  v_mov_b32 v104, 0
  v_mov_b32 v105, 0
  v_mov_b32 v106, 0
  v_mov_b32 v107, 0
  v_mov_b32 v108, 0
  v_mov_b32 v109, 0
  v_mov_b32 v110, 0
  v_mov_b32 v111, 0
  v_mov_b32 v112, 0
  v_mov_b32 v113, 0
  v_mov_b32 v114, 0
  v_mov_b32 v115, 0
  v_mov_b32 v116, 0
  v_mov_b32 v117, 0
  v_mov_b32 v118, 0
  v_mov_b32 v119, 0
  v_mov_b32 v120, 0
  v_mov_b32 v121, 0
  v_mov_b32 v122, 0
  v_mov_b32 v123, 0
  v_mov_b32 v124, 0
  v_mov_b32 v125, 0
  v_mov_b32 v126, 0
  v_mov_b32 v127, 0
  v_mov_b32 v128, 0
  v_mov_b32 v129, 0
  v_mov_b32 v130, 0
  v_mov_b32 v131, 0
  v_mov_b32 v132, 0
  v_mov_b32 v133, 0
  v_mov_b32 v134, 0
  v_mov_b32 v135, 0
  v_mov_b32 v136, 0
  v_mov_b32 v137, 0
  v_mov_b32 v138, 0
  v_mov_b32 v139, 0
  v_mov_b32 v140, 0
  v_mov_b32 v141, 0
  v_mov_b32 v142, 0
  v_mov_b32 v143, 0
  s_mul_i32 s51, s50, 8192
  s_mul_i32 s52, s50, 11008
  s_add_u32 s24, s51, 0
  s_add_u32 s28, s52, 0
  s_add_u32 s25, s51, 32768
  s_add_u32 s29, s52, 44032
  s_add_u32 s26, s51, 65536
  s_add_u32 s30, s52, 88064
  s_add_u32 s27, s51, 98304
  s_add_u32 s31, s52, 132096
  s_lshl_b32 s53, s50, 10
  s_add_u32 m0, s53, 0
  s_nop 0
  buffer_load_dwordx4 v3, s[4:7], s24 offen lds
  s_add_u32 m0, s53, 4096
  s_nop 0
  buffer_load_dwordx4 v3, s[4:7], s25 offen lds
  s_add_u32 m0, s53, 8192
  s_nop 0
  buffer_load_dwordx4 v3, s[4:7], s26 offen lds
  s_add_u32 m0, s53, 12288
  s_nop 0
  buffer_load_dwordx4 v3, s[4:7], s27 offen lds
  s_add_u32 m0, s53, 16384
  s_nop 0
  buffer_load_dwordx4 v4, s[8:11], s28 offen lds
  s_add_u32 m0, s53, 20480
  s_nop 0
  buffer_load_dwordx4 v4, s[8:11], s29 offen lds
  s_add_u32 m0, s53, 24576
  s_nop 0
  buffer_load_dwordx4 v4, s[8:11], s30 offen lds
  s_add_u32 m0, s53, 28672
  s_nop 0
  buffer_load_dwordx4 v4, s[8:11], s31 offen lds
  s_add_u32 s24, s24, 128
  s_add_u32 s28, s28, 176128
  s_add_u32 s25, s25, 128
  s_add_u32 s29, s29, 176128
  s_add_u32 s26, s26, 128
  s_add_u32 s30, s30, 176128
  s_add_u32 s27, s27, 128
  s_add_u32 s31, s31, 176128
  s_add_u32 m0, s53, 32768
  s_nop 0
  buffer_load_dwordx4 v3, s[4:7], s24 offen lds
  s_add_u32 m0, s53, 36864
  s_nop 0
  buffer_load_dwordx4 v3, s[4:7], s25 offen lds
  s_add_u32 m0, s53, 40960
  s_nop 0
  buffer_load_dwordx4 v3, s[4:7], s26 offen lds
  s_add_u32 m0, s53, 45056
  s_nop 0
  buffer_load_dwordx4 v3, s[4:7], s27 offen lds
  s_add_u32 m0, s53, 49152
  s_nop 0
  buffer_load_dwordx4 v4, s[8:11], s28 offen lds
  s_add_u32 m0, s53, 53248
  s_nop 0
  buffer_load_dwordx4 v4, s[8:11], s29 offen lds
  s_add_u32 m0, s53, 57344
  s_nop 0
  buffer_load_dwordx4 v4, s[8:11], s30 offen lds
  s_add_u32 m0, s53, 61440
  s_nop 0
  buffer_load_dwordx4 v4, s[8:11], s31 offen lds
  s_add_u32 s24, s24, 128
  s_add_u32 s28, s28, 176128
  s_add_u32 s25, s25, 128
  s_add_u32 s29, s29, 176128
  s_add_u32 s26, s26, 128
  s_add_u32 s30, s30, 176128
  s_add_u32 s27, s27, 128
  s_add_u32 s31, s31, 176128
  s_add_u32 m0, s53, 65536
  s_nop 0
  buffer_load_dwordx4 v3, s[4:7], s24 offen lds
  s_add_u32 m0, s53, 69632
  s_nop 0
  buffer_load_dwordx4 v3, s[4:7], s25 offen lds
  s_add_u32 m0, s53, 73728
  s_nop 0
  buffer_load_dwordx4 v3, s[4:7], s26 offen lds
  s_add_u32 m0, s53, 77824
  s_nop 0
  buffer_load_dwordx4 v3, s[4:7], s27 offen lds
  s_add_u32 m0, s53, 81920
  s_nop 0
  buffer_load_dwordx4 v4, s[8:11], s28 offen lds
  s_add_u32 m0, s53, 86016
  s_nop 0
  buffer_load_dwordx4 v4, s[8:11], s29 offen lds
  s_add_u32 m0, s53, 90112
  s_nop 0
  buffer_load_dwordx4 v4, s[8:11], s30 offen lds
  s_add_u32 m0, s53, 94208
  s_nop 0
  buffer_load_dwordx4 v4, s[8:11], s31 offen lds
  s_add_u32 s24, s24, 128
  s_add_u32 s28, s28, 176128
  s_add_u32 s25, s25, 128
  s_add_u32 s29, s29, 176128
  s_add_u32 s26, s26, 128
  s_add_u32 s30, s30, 176128
  s_add_u32 s27, s27, 128
  s_add_u32 s31, s31, 176128
  s_mov_b32 s22, 2
L_ffn1_kernel_loop:
  s_waitcnt vmcnt(16)
  s_barrier
  s_add_u32 m0, s53, 98304
  s_nop 0
  buffer_load_dwordx4 v3, s[4:7], s24 offen lds
  s_add_u32 m0, s53, 102400
  s_nop 0
  buffer_load_dwordx4 v3, s[4:7], s25 offen lds
  s_add_u32 m0, s53, 106496
  s_nop 0
  buffer_load_dwordx4 v3, s[4:7], s26 offen lds
  s_add_u32 m0, s53, 110592
  s_nop 0
  buffer_load_dwordx4 v3, s[4:7], s27 offen lds
  s_add_u32 m0, s53, 114688
  s_nop 0
  buffer_load_dwordx4 v4, s[8:11], s28 offen lds
  s_add_u32 m0, s53, 118784
  s_nop 0
  buffer_load_dwordx4 v4, s[8:11], s29 offen lds
  s_add_u32 m0, s53, 122880
  s_nop 0
  buffer_load_dwordx4 v4, s[8:11], s30 offen lds
  s_add_u32 m0, s53, 126976
  s_nop 0
  buffer_load_dwordx4 v4, s[8:11], s31 offen lds
  s_add_u32 s24, s24, 128
  s_add_u32 s28, s28, 176128
  s_add_u32 s25, s25, 128
  s_add_u32 s29, s29, 176128
  s_add_u32 s26, s26, 128
  s_add_u32 s30, s30, 176128
  s_add_u32 s27, s27, 128
  s_add_u32 s31, s31, 176128
  ds_read_b128 v[48:51], v12 offset:0
  ds_read_b128 v[52:55], v12 offset:4096
  ds_read_b64_tr_b16 v[56:57], v10 offset:0
  ds_read_b64_tr_b16 v[58:59], v10 offset:1024
  ds_read_b64_tr_b16 v[60:61], v11 offset:0
  ds_read_b64_tr_b16 v[62:63], v11 offset:1024
  ds_read_b128 v[64:67], v13 offset:0
  ds_read_b128 v[68:71], v13 offset:4096
  ds_read_b64_tr_b16 v[72:73], v10 offset:4096
  ds_read_b64_tr_b16 v[74:75], v10 offset:5120
  ds_read_b64_tr_b16 v[76:77], v11 offset:4096
  ds_read_b64_tr_b16 v[78:79], v11 offset:5120
  s_waitcnt lgkmcnt(6)
  v_mfma_f32_32x32x16_bf16 v[80:95], v[56:59], v[48:51], v[80:95]
  v_mfma_f32_32x32x16_bf16 v[96:111], v[56:59], v[52:55], v[96:111]
  v_mfma_f32_32x32x16_bf16 v[112:127], v[60:63], v[48:51], v[112:127]
  v_mfma_f32_32x32x16_bf16 v[128:143], v[60:63], v[52:55], v[128:143]
  ds_read_b128 v[48:51], v14 offset:0
  ds_read_b128 v[52:55], v14 offset:4096
  ds_read_b64_tr_b16 v[56:57], v10 offset:8192
  ds_read_b64_tr_b16 v[58:59], v10 offset:9216
  ds_read_b64_tr_b16 v[60:61], v11 offset:8192
  ds_read_b64_tr_b16 v[62:63], v11 offset:9216
  s_waitcnt lgkmcnt(6)
  v_mfma_f32_32x32x16_bf16 v[80:95], v[72:75], v[64:67], v[80:95]
  v_mfma_f32_32x32x16_bf16 v[96:111], v[72:75], v[68:71], v[96:111]
  v_mfma_f32_32x32x16_bf16 v[112:127], v[76:79], v[64:67], v[112:127]
  v_mfma_f32_32x32x16_bf16 v[128:143], v[76:79], v[68:71], v[128:143]
  ds_read_b128 v[64:67], v15 offset:0
  ds_read_b128 v[68:71], v15 offset:4096
  ds_read_b64_tr_b16 v[72:73], v10 offset:12288
  ds_read_b64_tr_b16 v[74:75], v10 offset:13312
  ds_read_b64_tr_b16 v[76:77], v11 offset:12288
  ds_read_b64_tr_b16 v[78:79], v11 offset:13312
  s_waitcnt lgkmcnt(6)
  v_mfma_f32_32x32x16_bf16 v[80:95], v[56:59], v[48:51], v[80:95]
  v_mfma_f32_32x32x16_bf16 v[96:111], v[56:59], v[52:55], v[96:111]
  v_mfma_f32_32x32x16_bf16 v[112:127], v[60:63], v[48:51], v[112:127]
  v_mfma_f32_32x32x16_bf16 v[128:143], v[60:63], v[52:55], v[128:143]
  s_waitcnt lgkmcnt(0)
  v_mfma_f32_32x32x16_bf16 v[80:95], v[72:75], v[64:67], v[80:95]
  v_mfma_f32_32x32x16_bf16 v[96:111], v[72:75], v[68:71], v[96:111]
  v_mfma_f32_32x32x16_bf16 v[112:127], v[76:79], v[64:67], v[112:127]
  v_mfma_f32_32x32x16_bf16 v[128:143], v[76:79], v[68:71], v[128:143]
  s_waitcnt vmcnt(16)
  s_barrier
  s_add_u32 m0, s53, 0
  s_nop 0
  buffer_load_dwordx4 v3, s[4:7], s24 offen lds
  s_add_u32 m0, s53, 4096
  s_nop 0
  buffer_load_dwordx4 v3, s[4:7], s25 offen lds
  s_add_u32 m0, s53, 8192
  s_nop 0
  buffer_load_dwordx4 v3, s[4:7], s26 offen lds
  s_add_u32 m0, s53, 12288
  s_nop 0
  buffer_load_dwordx4 v3, s[4:7], s27 offen lds
  s_add_u32 m0, s53, 16384
  s_nop 0
  buffer_load_dwordx4 v4, s[8:11], s28 offen lds
  s_add_u32 m0, s53, 20480
  s_nop 0
  buffer_load_dwordx4 v4, s[8:11], s29 offen lds
  s_add_u32 m0, s53, 24576
  s_nop 0
  buffer_load_dwordx4 v4, s[8:11], s30 offen lds
  s_add_u32 m0, s53, 28672
  s_nop 0
  buffer_load_dwordx4 v4, s[8:11], s31 offen lds
  s_add_u32 s24, s24, 128
  s_add_u32 s28, s28, 176128
  s_add_u32 s25, s25, 128
  s_add_u32 s29, s29, 176128
  s_add_u32 s26, s26, 128
  s_add_u32 s30, s30, 176128
  s_add_u32 s27, s27, 128
  s_add_u32 s31, s31, 176128
  ds_read_b128 v[48:51], v12 offset:32768
  ds_read_b128 v[52:55], v12 offset:36864
  ds_read_b64_tr_b16 v[56:57], v10 offset:32768
  ds_read_b64_tr_b16 v[58:59], v10 offset:33792
  ds_read_b64_tr_b16 v[60:61], v11 offset:32768
  ds_read_b64_tr_b16 v[62:63], v11 offset:33792
  ds_read_b128 v[64:67], v13 offset:32768
  ds_read_b128 v[68:71], v13 offset:36864
  ds_read_b64_tr_b16 v[72:73], v10 offset:36864
  ds_read_b64_tr_b16 v[74:75], v10 offset:37888
  ds_read_b64_tr_b16 v[76:77], v11 offset:36864
  ds_read_b64_tr_b16 v[78:79], v11 offset:37888
  s_waitcnt lgkmcnt(6)
  v_mfma_f32_32x32x16_bf16 v[80:95], v[56:59], v[48:51], v[80:95]
  v_mfma_f32_32x32x16_bf16 v[96:111], v[56:59], v[52:55], v[96:111]
  v_mfma_f32_32x32x16_bf16 v[112:127], v[60:63], v[48:51], v[112:127]
  v_mfma_f32_32x32x16_bf16 v[128:143], v[60:63], v[52:55], v[128:143]
  ds_read_b128 v[48:51], v14 offset:32768
  ds_read_b128 v[52:55], v14 offset:36864
  ds_read_b64_tr_b16 v[56:57], v10 offset:40960
  ds_read_b64_tr_b16 v[58:59], v10 offset:41984
  ds_read_b64_tr_b16 v[60:61], v11 offset:40960
  ds_read_b64_tr_b16 v[62:63], v11 offset:41984
  s_waitcnt lgkmcnt(6)
  v_mfma_f32_32x32x16_bf16 v[80:95], v[72:75], v[64:67], v[80:95]
  v_mfma_f32_32x32x16_bf16 v[96:111], v[72:75], v[68:71], v[96:111]
  v_mfma_f32_32x32x16_bf16 v[112:127], v[76:79], v[64:67], v[112:127]
  v_mfma_f32_32x32x16_bf16 v[128:143], v[76:79], v[68:71], v[128:143]
  ds_read_b128 v[64:67], v15 offset:32768
  ds_read_b128 v[68:71], v15 offset:36864
  ds_read_b64_tr_b16 v[72:73], v10 offset:45056
  ds_read_b64_tr_b16 v[74:75], v10 offset:46080
  ds_read_b64_tr_b16 v[76:77], v11 offset:45056
  ds_read_b64_tr_b16 v[78:79], v11 offset:46080
  s_waitcnt lgkmcnt(6)
  v_mfma_f32_32x32x16_bf16 v[80:95], v[56:59], v[48:51], v[80:95]
  v_mfma_f32_32x32x16_bf16 v[96:111], v[56:59], v[52:55], v[96:111]
  v_mfma_f32_32x32x16_bf16 v[112:127], v[60:63], v[48:51], v[112:127]
  v_mfma_f32_32x32x16_bf16 v[128:143], v[60:63], v[52:55], v[128:143]
  s_waitcnt lgkmcnt(0)
  v_mfma_f32_32x32x16_bf16 v[80:95], v[72:75], v[64:67], v[80:95]
  v_mfma_f32_32x32x16_bf16 v[96:111], v[72:75], v[68:71], v[96:111]
  v_mfma_f32_32x32x16_bf16 v[112:127], v[76:79], v[64:67], v[112:127]
  v_mfma_f32_32x32x16_bf16 v[128:143], v[76:79], v[68:71], v[128:143]
  s_waitcnt vmcnt(16)
  s_barrier
  s_add_u32 m0, s53, 32768
  s_nop 0
  buffer_load_dwordx4 v3, s[4:7], s24 offen lds
  s_add_u32 m0, s53, 36864
  s_nop 0
  buffer_load_dwordx4 v3, s[4:7], s25 offen lds
  s_add_u32 m0, s53, 40960
  s_nop 0
  buffer_load_dwordx4 v3, s[4:7], s26 offen lds
  s_add_u32 m0, s53, 45056
  s_nop 0
  buffer_load_dwordx4 v3, s[4:7], s27 offen lds
  s_add_u32 m0, s53, 49152
  s_nop 0
  buffer_load_dwordx4 v4, s[8:11], s28 offen lds
  s_add_u32 m0, s53, 53248
  s_nop 0
  buffer_load_dwordx4 v4, s[8:11], s29 offen lds
  s_add_u32 m0, s53, 57344
  s_nop 0
  buffer_load_dwordx4 v4, s[8:11], s30 offen lds
  s_add_u32 m0, s53, 61440
  s_nop 0
  buffer_load_dwordx4 v4, s[8:11], s31 offen lds
  s_add_u32 s24, s24, 128
  s_add_u32 s28, s28, 176128
  s_add_u32 s25, s25, 128
  s_add_u32 s29, s29, 176128
  s_add_u32 s26, s26, 128
  s_add_u32 s30, s30, 176128
  s_add_u32 s27, s27, 128
  s_add_u32 s31, s31, 176128
  ds_read_b128 v[48:51], v144 offset:0
  ds_read_b128 v[52:55], v144 offset:4096
  ds_read_b64_tr_b16 v[56:57], v148 offset:0
  ds_read_b64_tr_b16 v[58:59], v148 offset:1024
  ds_read_b64_tr_b16 v[60:61], v149 offset:0
  ds_read_b64_tr_b16 v[62:63], v149 offset:1024
  ds_read_b128 v[64:67], v145 offset:0
  ds_read_b128 v[68:71], v145 offset:4096
  ds_read_b64_tr_b16 v[72:73], v148 offset:4096
  ds_read_b64_tr_b16 v[74:75], v148 offset:5120
  ds_read_b64_tr_b16 v[76:77], v149 offset:4096
  ds_read_b64_tr_b16 v[78:79], v149 offset:5120
  s_waitcnt lgkmcnt(6)
  v_mfma_f32_32x32x16_bf16 v[80:95], v[56:59], v[48:51], v[80:95]
  v_mfma_f32_32x32x16_bf16 v[96:111], v[56:59], v[52:55], v[96:111]
  v_mfma_f32_32x32x16_bf16 v[112:127], v[60:63], v[48:51], v[112:127]
  v_mfma_f32_32x32x16_bf16 v[128:143], v[60:63], v[52:55], v[128:143]
  ds_read_b128 v[48:51], v146 offset:0
  ds_read_b128 v[52:55], v146 offset:4096
  ds_read_b64_tr_b16 v[56:57], v148 offset:8192
  ds_read_b64_tr_b16 v[58:59], v148 offset:9216
  ds_read_b64_tr_b16 v[60:61], v149 offset:8192
  ds_read_b64_tr_b16 v[62:63], v149 offset:9216
  s_waitcnt lgkmcnt(6)
  v_mfma_f32_32x32x16_bf16 v[80:95], v[72:75], v[64:67], v[80:95]
  v_mfma_f32_32x32x16_bf16 v[96:111], v[72:75], v[68:71], v[96:111]
  v_mfma_f32_32x32x16_bf16 v[112:127], v[76:79], v[64:67], v[112:127]
  v_mfma_f32_32x32x16_bf16 v[128:143], v[76:79], v[68:71], v[128:143]
  ds_read_b128 v[64:67], v147 offset:0
  ds_read_b128 v[68:71], v147 offset:4096
  ds_read_b64_tr_b16 v[72:73], v148 offset:12288
  ds_read_b64_tr_b16 v[74:75], v148 offset:13312
  ds_read_b64_tr_b16 v[76:77], v149 offset:12288
  ds_read_b64_tr_b16 v[78:79], v149 offset:13312
  s_waitcnt lgkmcnt(6)
  v_mfma_f32_32x32x16_bf16 v[80:95], v[56:59], v[48:51], v[80:95]
  v_mfma_f32_32x32x16_bf16 v[96:111], v[56:59], v[52:55], v[96:111]
  v_mfma_f32_32x32x16_bf16 v[112:127], v[60:63], v[48:51], v[112:127]
  v_mfma_f32_32x32x16_bf16 v[128:143], v[60:63], v[52:55], v[128:143]
  s_waitcnt lgkmcnt(0)
  v_mfma_f32_32x32x16_bf16 v[80:95], v[72:75], v[64:67], v[80:95]
  v_mfma_f32_32x32x16_bf16 v[96:111], v[72:75], v[68:71], v[96:111]
  v_mfma_f32_32x32x16_bf16 v[112:127], v[76:79], v[64:67], v[112:127]
  v_mfma_f32_32x32x16_bf16 v[128:143], v[76:79], v[68:71], v[128:143]
  s_waitcnt vmcnt(16)
  s_barrier
  s_add_u32 m0, s53, 65536
  s_nop 0
  buffer_load_dwordx4 v3, s[4:7], s24 offen lds
  s_add_u32 m0, s53, 69632
  s_nop 0
  buffer_load_dwordx4 v3, s[4:7], s25 offen lds
  s_add_u32 m0, s53, 73728
  s_nop 0
  buffer_load_dwordx4 v3, s[4:7], s26 offen lds
  s_add_u32 m0, s53, 77824
  s_nop 0
  buffer_load_dwordx4 v3, s[4:7], s27 offen lds
  s_add_u32 m0, s53, 81920
  s_nop 0
  buffer_load_dwordx4 v4, s[8:11], s28 offen lds
  s_add_u32 m0, s53, 86016
  s_nop 0
  buffer_load_dwordx4 v4, s[8:11], s29 offen lds
  s_add_u32 m0, s53, 90112
  s_nop 0
  buffer_load_dwordx4 v4, s[8:11], s30 offen lds
  s_add_u32 m0, s53, 94208
  s_nop 0
  buffer_load_dwordx4 v4, s[8:11], s31 offen lds
  s_add_u32 s24, s24, 128
  s_add_u32 s28, s28, 176128
  s_add_u32 s25, s25, 128
  s_add_u32 s29, s29, 176128
  s_add_u32 s26, s26, 128
  s_add_u32 s30, s30, 176128
  s_add_u32 s27, s27, 128
  s_add_u32 s31, s31, 176128
  ds_read_b128 v[48:51], v144 offset:32768
  ds_read_b128 v[52:55], v144 offset:36864
  ds_read_b64_tr_b16 v[56:57], v148 offset:32768
  ds_read_b64_tr_b16 v[58:59], v148 offset:33792
  ds_read_b64_tr_b16 v[60:61], v149 offset:32768
  ds_read_b64_tr_b16 v[62:63], v149 offset:33792
  ds_read_b128 v[64:67], v145 offset:32768
  ds_read_b128 v[68:71], v145 offset:36864
  ds_read_b64_tr_b16 v[72:73], v148 offset:36864
  ds_read_b64_tr_b16 v[74:75], v148 offset:37888
  ds_read_b64_tr_b16 v[76:77], v149 offset:36864
  ds_read_b64_tr_b16 v[78:79], v149 offset:37888
  s_waitcnt lgkmcnt(6)
  v_mfma_f32_32x32x16_bf16 v[80:95], v[56:59], v[48:51], v[80:95]
  v_mfma_f32_32x32x16_bf16 v[96:111], v[56:59], v[52:55], v[96:111]
  v_mfma_f32_32x32x16_bf16 v[112:127], v[60:63], v[48:51], v[112:127]
  v_mfma_f32_32x32x16_bf16 v[128:143], v[60:63], v[52:55], v[128:143]
  ds_read_b128 v[48:51], v146 offset:32768
  ds_read_b128 v[52:55], v146 offset:36864
  ds_read_b64_tr_b16 v[56:57], v148 offset:40960
  ds_read_b64_tr_b16 v[58:59], v148 offset:41984
  ds_read_b64_tr_b16 v[60:61], v149 offset:40960
  ds_read_b64_tr_b16 v[62:63], v149 offset:41984
  s_waitcnt lgkmcnt(6)
  v_mfma_f32_32x32x16_bf16 v[80:95], v[72:75], v[64:67], v[80:95]
  v_mfma_f32_32x32x16_bf16 v[96:111], v[72:75], v[68:71], v[96:111]
  v_mfma_f32_32x32x16_bf16 v[112:127], v[76:79], v[64:67], v[112:127]
  v_mfma_f32_32x32x16_bf16 v[128:143], v[76:79], v[68:71], v[128:143]
  ds_read_b128 v[64:67], v147 offset:32768
  ds_read_b128 v[68:71], v147 offset:36864
  ds_read_b64_tr_b16 v[72:73], v148 offset:45056
  ds_read_b64_tr_b16 v[74:75], v148 offset:46080
  ds_read_b64_tr_b16 v[76:77], v149 offset:45056
  ds_read_b64_tr_b16 v[78:79], v149 offset:46080
  s_waitcnt lgkmcnt(6)
  v_mfma_f32_32x32x16_bf16 v[80:95], v[56:59], v[48:51], v[80:95]
  v_mfma_f32_32x32x16_bf16 v[96:111], v[56:59], v[52:55], v[96:111]
  v_mfma_f32_32x32x16_bf16 v[112:127], v[60:63], v[48:51], v[112:127]
  v_mfma_f32_32x32x16_bf16 v[128:143], v[60:63], v[52:55], v[128:143]
  s_waitcnt lgkmcnt(0)
  v_mfma_f32_32x32x16_bf16 v[80:95], v[72:75], v[64:67], v[80:95]
  v_mfma_f32_32x32x16_bf16 v[96:111], v[72:75], v[68:71], v[96:111]
  v_mfma_f32_32x32x16_bf16 v[112:127], v[76:79], v[64:67], v[112:127]
  v_mfma_f32_32x32x16_bf16 v[128:143], v[76:79], v[68:71], v[128:143]
  s_sub_u32 s22, s22, 1
  s_cmp_lg_u32 s22, 0
  s_cbranch_scc1 L_ffn1_kernel_loop
  s_waitcnt vmcnt(0)
  s_barrier
  s_nop 7
  s_nop 7
  s_mov_b32 s36, 0x3dd2d3e8
  v_mov_b32 v31, 0x40135761
  v_and_b32 v9, 63, v0
  v_and_b32 v1, 31, v9
  v_lshrrev_b32 v2, 5, v9
  v_lshrrev_b32 v8, 6, v0
  v_lshrrev_b32 v7, 1, v8
  v_and_b32 v8, 1, v8

  v_lshlrev_b32 v15, 3, v2
  v_lshl_add_u32 v15, v8, 7, v15

  v_and_b32 v9, 63, v0
  v_and_b32 v1, 31, v9
  v_lshrrev_b32 v2, 5, v9
  v_lshrrev_b32 v8, 6, v0
  v_lshrrev_b32 v7, 1, v8
  v_and_b32 v8, 1, v8

  v_lshl_add_u32 v3, v7, 6, v1
  v_mul_u32_u24 v3, 272, v3
  v_lshlrev_b32 v4, 3, v2
  v_lshl_add_u32 v4, v8, 7, v4
  v_add_u32 v3, v3, v4
  v_lshrrev_b32 v5, 4, v0
  v_and_b32 v6, 15, v0
  v_mul_u32_u24 v4, 272, v5
  v_lshl_add_u32 v4, v6, 4, v4
  v_mul_u32_u24 v5, 2816, v5
  v_lshl_add_u32 v5, v6, 4, v5

  buffer_load_dwordx2 v[18:19], v15, s[56:59], 0 offen offset:0
  s_waitcnt vmcnt(0)
  v_cvt_pk_bf16_f32 v20, v80, v81
  v_cvt_pk_bf16_f32 v21, v82, v83
  v_lshlrev_b32 v22, 16, v20
  v_lshlrev_b32 v26, 16, v18
  v_and_b32 v23, 0xffff0000, v20
  v_and_b32 v27, 0xffff0000, v18
  v_lshlrev_b32 v24, 16, v21
  v_lshlrev_b32 v28, 16, v19
  v_and_b32 v25, 0xffff0000, v21
  v_and_b32 v29, 0xffff0000, v19
  v_add_f32 v22, v22, v26
  v_add_f32 v23, v23, v27
  v_add_f32 v24, v24, v28
  v_add_f32 v25, v25, v29
  v_cvt_pk_bf16_f32 v20, v22, v23
  v_cvt_pk_bf16_f32 v21, v24, v25
  v_lshlrev_b32 v22, 16, v20
  v_and_b32 v23, 0xffff0000, v20
  v_lshlrev_b32 v24, 16, v21
  v_and_b32 v25, 0xffff0000, v21
  v_mul_f32 v26, v22, v22
  v_fma_f32 v26, v26, s36, v31
  v_mul_f32 v26, v26, v22
  v_exp_f32 v26, v26
  v_mul_f32 v27, v23, v23
  v_fma_f32 v27, v27, s36, v31
  v_mul_f32 v27, v27, v23
  v_exp_f32 v27, v27
  v_mul_f32 v28, v24, v24
  v_fma_f32 v28, v28, s36, v31
  v_mul_f32 v28, v28, v24
  v_exp_f32 v28, v28
  v_mul_f32 v29, v25, v25
  v_fma_f32 v29, v29, s36, v31
  v_mul_f32 v29, v29, v25
  v_exp_f32 v29, v29
  s_nop 0
  v_add_f32 v26, 1.0, v26
  v_rcp_f32 v26, v26
  v_add_f32 v27, 1.0, v27
  v_rcp_f32 v27, v27
  v_add_f32 v28, 1.0, v28
  v_rcp_f32 v28, v28
  v_add_f32 v29, 1.0, v29
  v_rcp_f32 v29, v29
  s_nop 0
  v_mul_f32 v26, v26, v22
  v_sub_f32 v80, v22, v26
  v_mul_f32 v27, v27, v23
  v_sub_f32 v81, v23, v27
  v_mul_f32 v28, v28, v24
  v_sub_f32 v82, v24, v28
  v_mul_f32 v29, v29, v25
  v_sub_f32 v83, v25, v29
  v_cvt_pk_bf16_f32 v16, v80, v81
  v_cvt_pk_bf16_f32 v17, v82, v83
  ds_write_b64 v3, v[16:17] offset:0
  buffer_load_dwordx2 v[18:19], v15, s[56:59], 0 offen offset:16
  s_waitcnt vmcnt(0)
  v_cvt_pk_bf16_f32 v20, v84, v85
  v_cvt_pk_bf16_f32 v21, v86, v87
  v_lshlrev_b32 v22, 16, v20
  v_lshlrev_b32 v26, 16, v18
  v_and_b32 v23, 0xffff0000, v20
  v_and_b32 v27, 0xffff0000, v18
  v_lshlrev_b32 v24, 16, v21
  v_lshlrev_b32 v28, 16, v19
  v_and_b32 v25, 0xffff0000, v21
  v_and_b32 v29, 0xffff0000, v19
  v_add_f32 v22, v22, v26
  v_add_f32 v23, v23, v27
  v_add_f32 v24, v24, v28
  v_add_f32 v25, v25, v29
  v_cvt_pk_bf16_f32 v20, v22, v23
  v_cvt_pk_bf16_f32 v21, v24, v25
  v_lshlrev_b32 v22, 16, v20
  v_and_b32 v23, 0xffff0000, v20
  v_lshlrev_b32 v24, 16, v21
  v_and_b32 v25, 0xffff0000, v21
  v_mul_f32 v26, v22, v22
  v_fma_f32 v26, v26, s36, v31
  v_mul_f32 v26, v26, v22
  v_exp_f32 v26, v26
  v_mul_f32 v27, v23, v23
  v_fma_f32 v27, v27, s36, v31
  v_mul_f32 v27, v27, v23
  v_exp_f32 v27, v27
  v_mul_f32 v28, v24, v24
  v_fma_f32 v28, v28, s36, v31
  v_mul_f32 v28, v28, v24
  v_exp_f32 v28, v28
  v_mul_f32 v29, v25, v25
  v_fma_f32 v29, v29, s36, v31
  v_mul_f32 v29, v29, v25
  v_exp_f32 v29, v29
  s_nop 0
  v_add_f32 v26, 1.0, v26
  v_rcp_f32 v26, v26
  v_add_f32 v27, 1.0, v27
  v_rcp_f32 v27, v27
  v_add_f32 v28, 1.0, v28
  v_rcp_f32 v28, v28
  v_add_f32 v29, 1.0, v29
  v_rcp_f32 v29, v29
  s_nop 0
  v_mul_f32 v26, v26, v22
  v_sub_f32 v84, v22, v26
  v_mul_f32 v27, v27, v23
  v_sub_f32 v85, v23, v27
  v_mul_f32 v28, v28, v24
  v_sub_f32 v86, v24, v28
  v_mul_f32 v29, v29, v25
  v_sub_f32 v87, v25, v29
  v_cvt_pk_bf16_f32 v16, v84, v85
  v_cvt_pk_bf16_f32 v17, v86, v87
  ds_write_b64 v3, v[16:17] offset:16
  buffer_load_dwordx2 v[18:19], v15, s[56:59], 0 offen offset:32
  s_waitcnt vmcnt(0)
  v_cvt_pk_bf16_f32 v20, v88, v89
  v_cvt_pk_bf16_f32 v21, v90, v91
  v_lshlrev_b32 v22, 16, v20
  v_lshlrev_b32 v26, 16, v18
  v_and_b32 v23, 0xffff0000, v20
  v_and_b32 v27, 0xffff0000, v18
  v_lshlrev_b32 v24, 16, v21
  v_lshlrev_b32 v28, 16, v19
  v_and_b32 v25, 0xffff0000, v21
  v_and_b32 v29, 0xffff0000, v19
  v_add_f32 v22, v22, v26
  v_add_f32 v23, v23, v27
  v_add_f32 v24, v24, v28
  v_add_f32 v25, v25, v29
  v_cvt_pk_bf16_f32 v20, v22, v23
  v_cvt_pk_bf16_f32 v21, v24, v25
  v_lshlrev_b32 v22, 16, v20
  v_and_b32 v23, 0xffff0000, v20
  v_lshlrev_b32 v24, 16, v21
  v_and_b32 v25, 0xffff0000, v21
  v_mul_f32 v26, v22, v22
  v_fma_f32 v26, v26, s36, v31
  v_mul_f32 v26, v26, v22
  v_exp_f32 v26, v26
  v_mul_f32 v27, v23, v23
  v_fma_f32 v27, v27, s36, v31
  v_mul_f32 v27, v27, v23
  v_exp_f32 v27, v27
  v_mul_f32 v28, v24, v24
  v_fma_f32 v28, v28, s36, v31
  v_mul_f32 v28, v28, v24
  v_exp_f32 v28, v28
  v_mul_f32 v29, v25, v25
  v_fma_f32 v29, v29, s36, v31
  v_mul_f32 v29, v29, v25
  v_exp_f32 v29, v29
  s_nop 0
  v_add_f32 v26, 1.0, v26
  v_rcp_f32 v26, v26
  v_add_f32 v27, 1.0, v27
  v_rcp_f32 v27, v27
  v_add_f32 v28, 1.0, v28
  v_rcp_f32 v28, v28
  v_add_f32 v29, 1.0, v29
  v_rcp_f32 v29, v29
  s_nop 0
  v_mul_f32 v26, v26, v22
  v_sub_f32 v88, v22, v26
  v_mul_f32 v27, v27, v23
  v_sub_f32 v89, v23, v27
  v_mul_f32 v28, v28, v24
  v_sub_f32 v90, v24, v28
  v_mul_f32 v29, v29, v25
  v_sub_f32 v91, v25, v29
  v_cvt_pk_bf16_f32 v16, v88, v89
  v_cvt_pk_bf16_f32 v17, v90, v91
  ds_write_b64 v3, v[16:17] offset:32
  buffer_load_dwordx2 v[18:19], v15, s[56:59], 0 offen offset:48
  s_waitcnt vmcnt(0)
  v_cvt_pk_bf16_f32 v20, v92, v93
  v_cvt_pk_bf16_f32 v21, v94, v95
  v_lshlrev_b32 v22, 16, v20
  v_lshlrev_b32 v26, 16, v18
  v_and_b32 v23, 0xffff0000, v20
  v_and_b32 v27, 0xffff0000, v18
  v_lshlrev_b32 v24, 16, v21
  v_lshlrev_b32 v28, 16, v19
  v_and_b32 v25, 0xffff0000, v21
  v_and_b32 v29, 0xffff0000, v19
  v_add_f32 v22, v22, v26
  v_add_f32 v23, v23, v27
  v_add_f32 v24, v24, v28
  v_add_f32 v25, v25, v29
  v_cvt_pk_bf16_f32 v20, v22, v23
  v_cvt_pk_bf16_f32 v21, v24, v25
  v_lshlrev_b32 v22, 16, v20
  v_and_b32 v23, 0xffff0000, v20
  v_lshlrev_b32 v24, 16, v21
  v_and_b32 v25, 0xffff0000, v21
  v_mul_f32 v26, v22, v22
  v_fma_f32 v26, v26, s36, v31
  v_mul_f32 v26, v26, v22
  v_exp_f32 v26, v26
  v_mul_f32 v27, v23, v23
  v_fma_f32 v27, v27, s36, v31
  v_mul_f32 v27, v27, v23
  v_exp_f32 v27, v27
  v_mul_f32 v28, v24, v24
  v_fma_f32 v28, v28, s36, v31
  v_mul_f32 v28, v28, v24
  v_exp_f32 v28, v28
  v_mul_f32 v29, v25, v25
  v_fma_f32 v29, v29, s36, v31
  v_mul_f32 v29, v29, v25
  v_exp_f32 v29, v29
  s_nop 0
  v_add_f32 v26, 1.0, v26
  v_rcp_f32 v26, v26
  v_add_f32 v27, 1.0, v27
  v_rcp_f32 v27, v27
  v_add_f32 v28, 1.0, v28
  v_rcp_f32 v28, v28
  v_add_f32 v29, 1.0, v29
  v_rcp_f32 v29, v29
  s_nop 0
  v_mul_f32 v26, v26, v22
  v_sub_f32 v92, v22, v26
  v_mul_f32 v27, v27, v23
  v_sub_f32 v93, v23, v27
  v_mul_f32 v28, v28, v24
  v_sub_f32 v94, v24, v28
  v_mul_f32 v29, v29, v25
  v_sub_f32 v95, v25, v29
  v_cvt_pk_bf16_f32 v16, v92, v93
  v_cvt_pk_bf16_f32 v17, v94, v95
  ds_write_b64 v3, v[16:17] offset:48
  buffer_load_dwordx2 v[18:19], v15, s[56:59], 0 offen offset:0
  s_waitcnt vmcnt(0)
  v_cvt_pk_bf16_f32 v20, v96, v97
  v_cvt_pk_bf16_f32 v21, v98, v99
  v_lshlrev_b32 v22, 16, v20
  v_lshlrev_b32 v26, 16, v18
  v_and_b32 v23, 0xffff0000, v20
  v_and_b32 v27, 0xffff0000, v18
  v_lshlrev_b32 v24, 16, v21
  v_lshlrev_b32 v28, 16, v19
  v_and_b32 v25, 0xffff0000, v21
  v_and_b32 v29, 0xffff0000, v19
  v_add_f32 v22, v22, v26
  v_add_f32 v23, v23, v27
  v_add_f32 v24, v24, v28
  v_add_f32 v25, v25, v29
  v_cvt_pk_bf16_f32 v20, v22, v23
  v_cvt_pk_bf16_f32 v21, v24, v25
  v_lshlrev_b32 v22, 16, v20
  v_and_b32 v23, 0xffff0000, v20
  v_lshlrev_b32 v24, 16, v21
  v_and_b32 v25, 0xffff0000, v21
  v_mul_f32 v26, v22, v22
  v_fma_f32 v26, v26, s36, v31
  v_mul_f32 v26, v26, v22
  v_exp_f32 v26, v26
  v_mul_f32 v27, v23, v23
  v_fma_f32 v27, v27, s36, v31
  v_mul_f32 v27, v27, v23
  v_exp_f32 v27, v27
  v_mul_f32 v28, v24, v24
  v_fma_f32 v28, v28, s36, v31
  v_mul_f32 v28, v28, v24
  v_exp_f32 v28, v28
  v_mul_f32 v29, v25, v25
  v_fma_f32 v29, v29, s36, v31
  v_mul_f32 v29, v29, v25
  v_exp_f32 v29, v29
  s_nop 0
  v_add_f32 v26, 1.0, v26
  v_rcp_f32 v26, v26
  v_add_f32 v27, 1.0, v27
  v_rcp_f32 v27, v27
  v_add_f32 v28, 1.0, v28
  v_rcp_f32 v28, v28
  v_add_f32 v29, 1.0, v29
  v_rcp_f32 v29, v29
  s_nop 0
  v_mul_f32 v26, v26, v22
  v_sub_f32 v96, v22, v26
  v_mul_f32 v27, v27, v23
  v_sub_f32 v97, v23, v27
  v_mul_f32 v28, v28, v24
  v_sub_f32 v98, v24, v28
  v_mul_f32 v29, v29, v25
  v_sub_f32 v99, v25, v29
  v_cvt_pk_bf16_f32 v16, v96, v97
  v_cvt_pk_bf16_f32 v17, v98, v99
  ds_write_b64 v3, v[16:17] offset:8704
  buffer_load_dwordx2 v[18:19], v15, s[56:59], 0 offen offset:16
  s_waitcnt vmcnt(0)
  v_cvt_pk_bf16_f32 v20, v100, v101
  v_cvt_pk_bf16_f32 v21, v102, v103
  v_lshlrev_b32 v22, 16, v20
  v_lshlrev_b32 v26, 16, v18
  v_and_b32 v23, 0xffff0000, v20
  v_and_b32 v27, 0xffff0000, v18
  v_lshlrev_b32 v24, 16, v21
  v_lshlrev_b32 v28, 16, v19
  v_and_b32 v25, 0xffff0000, v21
  v_and_b32 v29, 0xffff0000, v19
  v_add_f32 v22, v22, v26
  v_add_f32 v23, v23, v27
  v_add_f32 v24, v24, v28
  v_add_f32 v25, v25, v29
  v_cvt_pk_bf16_f32 v20, v22, v23
  v_cvt_pk_bf16_f32 v21, v24, v25
  v_lshlrev_b32 v22, 16, v20
  v_and_b32 v23, 0xffff0000, v20
  v_lshlrev_b32 v24, 16, v21
  v_and_b32 v25, 0xffff0000, v21
  v_mul_f32 v26, v22, v22
  v_fma_f32 v26, v26, s36, v31
  v_mul_f32 v26, v26, v22
  v_exp_f32 v26, v26
  v_mul_f32 v27, v23, v23
  v_fma_f32 v27, v27, s36, v31
  v_mul_f32 v27, v27, v23
  v_exp_f32 v27, v27
  v_mul_f32 v28, v24, v24
  v_fma_f32 v28, v28, s36, v31
  v_mul_f32 v28, v28, v24
  v_exp_f32 v28, v28
  v_mul_f32 v29, v25, v25
  v_fma_f32 v29, v29, s36, v31
  v_mul_f32 v29, v29, v25
  v_exp_f32 v29, v29
  s_nop 0
  v_add_f32 v26, 1.0, v26
  v_rcp_f32 v26, v26
  v_add_f32 v27, 1.0, v27
  v_rcp_f32 v27, v27
  v_add_f32 v28, 1.0, v28
  v_rcp_f32 v28, v28
  v_add_f32 v29, 1.0, v29
  v_rcp_f32 v29, v29
  s_nop 0
  v_mul_f32 v26, v26, v22
  v_sub_f32 v100, v22, v26
  v_mul_f32 v27, v27, v23
  v_sub_f32 v101, v23, v27
  v_mul_f32 v28, v28, v24
  v_sub_f32 v102, v24, v28
  v_mul_f32 v29, v29, v25
  v_sub_f32 v103, v25, v29
  v_cvt_pk_bf16_f32 v16, v100, v101
  v_cvt_pk_bf16_f32 v17, v102, v103
  ds_write_b64 v3, v[16:17] offset:8720
  buffer_load_dwordx2 v[18:19], v15, s[56:59], 0 offen offset:32
  s_waitcnt vmcnt(0)
  v_cvt_pk_bf16_f32 v20, v104, v105
  v_cvt_pk_bf16_f32 v21, v106, v107
  v_lshlrev_b32 v22, 16, v20
  v_lshlrev_b32 v26, 16, v18
  v_and_b32 v23, 0xffff0000, v20
  v_and_b32 v27, 0xffff0000, v18
  v_lshlrev_b32 v24, 16, v21
  v_lshlrev_b32 v28, 16, v19
  v_and_b32 v25, 0xffff0000, v21
  v_and_b32 v29, 0xffff0000, v19
  v_add_f32 v22, v22, v26
  v_add_f32 v23, v23, v27
  v_add_f32 v24, v24, v28
  v_add_f32 v25, v25, v29
  v_cvt_pk_bf16_f32 v20, v22, v23
  v_cvt_pk_bf16_f32 v21, v24, v25
  v_lshlrev_b32 v22, 16, v20
  v_and_b32 v23, 0xffff0000, v20
  v_lshlrev_b32 v24, 16, v21
  v_and_b32 v25, 0xffff0000, v21
  v_mul_f32 v26, v22, v22
  v_fma_f32 v26, v26, s36, v31
  v_mul_f32 v26, v26, v22
  v_exp_f32 v26, v26
  v_mul_f32 v27, v23, v23
  v_fma_f32 v27, v27, s36, v31
  v_mul_f32 v27, v27, v23
  v_exp_f32 v27, v27
  v_mul_f32 v28, v24, v24
  v_fma_f32 v28, v28, s36, v31
  v_mul_f32 v28, v28, v24
  v_exp_f32 v28, v28
  v_mul_f32 v29, v25, v25
  v_fma_f32 v29, v29, s36, v31
  v_mul_f32 v29, v29, v25
  v_exp_f32 v29, v29
  s_nop 0
  v_add_f32 v26, 1.0, v26
  v_rcp_f32 v26, v26
  v_add_f32 v27, 1.0, v27
  v_rcp_f32 v27, v27
  v_add_f32 v28, 1.0, v28
  v_rcp_f32 v28, v28
  v_add_f32 v29, 1.0, v29
  v_rcp_f32 v29, v29
  s_nop 0
  v_mul_f32 v26, v26, v22
  v_sub_f32 v104, v22, v26
  v_mul_f32 v27, v27, v23
  v_sub_f32 v105, v23, v27
  v_mul_f32 v28, v28, v24
  v_sub_f32 v106, v24, v28
  v_mul_f32 v29, v29, v25
  v_sub_f32 v107, v25, v29
  v_cvt_pk_bf16_f32 v16, v104, v105
  v_cvt_pk_bf16_f32 v17, v106, v107
  ds_write_b64 v3, v[16:17] offset:8736
  buffer_load_dwordx2 v[18:19], v15, s[56:59], 0 offen offset:48
  s_waitcnt vmcnt(0)
  v_cvt_pk_bf16_f32 v20, v108, v109
  v_cvt_pk_bf16_f32 v21, v110, v111
  v_lshlrev_b32 v22, 16, v20
  v_lshlrev_b32 v26, 16, v18
  v_and_b32 v23, 0xffff0000, v20
  v_and_b32 v27, 0xffff0000, v18
  v_lshlrev_b32 v24, 16, v21
  v_lshlrev_b32 v28, 16, v19
  v_and_b32 v25, 0xffff0000, v21
  v_and_b32 v29, 0xffff0000, v19
  v_add_f32 v22, v22, v26
  v_add_f32 v23, v23, v27
  v_add_f32 v24, v24, v28
  v_add_f32 v25, v25, v29
  v_cvt_pk_bf16_f32 v20, v22, v23
  v_cvt_pk_bf16_f32 v21, v24, v25
  v_lshlrev_b32 v22, 16, v20
  v_and_b32 v23, 0xffff0000, v20
  v_lshlrev_b32 v24, 16, v21
  v_and_b32 v25, 0xffff0000, v21
  v_mul_f32 v26, v22, v22
  v_fma_f32 v26, v26, s36, v31
  v_mul_f32 v26, v26, v22
  v_exp_f32 v26, v26
  v_mul_f32 v27, v23, v23
  v_fma_f32 v27, v27, s36, v31
  v_mul_f32 v27, v27, v23
  v_exp_f32 v27, v27
  v_mul_f32 v28, v24, v24
  v_fma_f32 v28, v28, s36, v31
  v_mul_f32 v28, v28, v24
  v_exp_f32 v28, v28
  v_mul_f32 v29, v25, v25
  v_fma_f32 v29, v29, s36, v31
  v_mul_f32 v29, v29, v25
  v_exp_f32 v29, v29
  s_nop 0
  v_add_f32 v26, 1.0, v26
  v_rcp_f32 v26, v26
  v_add_f32 v27, 1.0, v27
  v_rcp_f32 v27, v27
  v_add_f32 v28, 1.0, v28
  v_rcp_f32 v28, v28
  v_add_f32 v29, 1.0, v29
  v_rcp_f32 v29, v29
  s_nop 0
  v_mul_f32 v26, v26, v22
  v_sub_f32 v108, v22, v26
  v_mul_f32 v27, v27, v23
  v_sub_f32 v109, v23, v27
  v_mul_f32 v28, v28, v24
  v_sub_f32 v110, v24, v28
  v_mul_f32 v29, v29, v25
  v_sub_f32 v111, v25, v29
  v_cvt_pk_bf16_f32 v16, v108, v109
  v_cvt_pk_bf16_f32 v17, v110, v111
  ds_write_b64 v3, v[16:17] offset:8752
  buffer_load_dwordx2 v[18:19], v15, s[56:59], 0 offen offset:64
  s_waitcnt vmcnt(0)
  v_cvt_pk_bf16_f32 v20, v112, v113
  v_cvt_pk_bf16_f32 v21, v114, v115
  v_lshlrev_b32 v22, 16, v20
  v_lshlrev_b32 v26, 16, v18
  v_and_b32 v23, 0xffff0000, v20
  v_and_b32 v27, 0xffff0000, v18
  v_lshlrev_b32 v24, 16, v21
  v_lshlrev_b32 v28, 16, v19
  v_and_b32 v25, 0xffff0000, v21
  v_and_b32 v29, 0xffff0000, v19
  v_add_f32 v22, v22, v26
  v_add_f32 v23, v23, v27
  v_add_f32 v24, v24, v28
  v_add_f32 v25, v25, v29
  v_cvt_pk_bf16_f32 v20, v22, v23
  v_cvt_pk_bf16_f32 v21, v24, v25
  v_lshlrev_b32 v22, 16, v20
  v_and_b32 v23, 0xffff0000, v20
  v_lshlrev_b32 v24, 16, v21
  v_and_b32 v25, 0xffff0000, v21
  v_mul_f32 v26, v22, v22
  v_fma_f32 v26, v26, s36, v31
  v_mul_f32 v26, v26, v22
  v_exp_f32 v26, v26
  v_mul_f32 v27, v23, v23
  v_fma_f32 v27, v27, s36, v31
  v_mul_f32 v27, v27, v23
  v_exp_f32 v27, v27
  v_mul_f32 v28, v24, v24
  v_fma_f32 v28, v28, s36, v31
  v_mul_f32 v28, v28, v24
  v_exp_f32 v28, v28
  v_mul_f32 v29, v25, v25
  v_fma_f32 v29, v29, s36, v31
  v_mul_f32 v29, v29, v25
  v_exp_f32 v29, v29
  s_nop 0
  v_add_f32 v26, 1.0, v26
  v_rcp_f32 v26, v26
  v_add_f32 v27, 1.0, v27
  v_rcp_f32 v27, v27
  v_add_f32 v28, 1.0, v28
  v_rcp_f32 v28, v28
  v_add_f32 v29, 1.0, v29
  v_rcp_f32 v29, v29
  s_nop 0
  v_mul_f32 v26, v26, v22
  v_sub_f32 v112, v22, v26
  v_mul_f32 v27, v27, v23
  v_sub_f32 v113, v23, v27
  v_mul_f32 v28, v28, v24
  v_sub_f32 v114, v24, v28
  v_mul_f32 v29, v29, v25
  v_sub_f32 v115, v25, v29
  v_cvt_pk_bf16_f32 v16, v112, v113
  v_cvt_pk_bf16_f32 v17, v114, v115
  ds_write_b64 v3, v[16:17] offset:64
  buffer_load_dwordx2 v[18:19], v15, s[56:59], 0 offen offset:80
  s_waitcnt vmcnt(0)
  v_cvt_pk_bf16_f32 v20, v116, v117
  v_cvt_pk_bf16_f32 v21, v118, v119
  v_lshlrev_b32 v22, 16, v20
  v_lshlrev_b32 v26, 16, v18
  v_and_b32 v23, 0xffff0000, v20
  v_and_b32 v27, 0xffff0000, v18
  v_lshlrev_b32 v24, 16, v21
  v_lshlrev_b32 v28, 16, v19
  v_and_b32 v25, 0xffff0000, v21
  v_and_b32 v29, 0xffff0000, v19
  v_add_f32 v22, v22, v26
  v_add_f32 v23, v23, v27
  v_add_f32 v24, v24, v28
  v_add_f32 v25, v25, v29
  v_cvt_pk_bf16_f32 v20, v22, v23
  v_cvt_pk_bf16_f32 v21, v24, v25
  v_lshlrev_b32 v22, 16, v20
  v_and_b32 v23, 0xffff0000, v20
  v_lshlrev_b32 v24, 16, v21
  v_and_b32 v25, 0xffff0000, v21
  v_mul_f32 v26, v22, v22
  v_fma_f32 v26, v26, s36, v31
  v_mul_f32 v26, v26, v22
  v_exp_f32 v26, v26
  v_mul_f32 v27, v23, v23
  v_fma_f32 v27, v27, s36, v31
  v_mul_f32 v27, v27, v23
  v_exp_f32 v27, v27
  v_mul_f32 v28, v24, v24
  v_fma_f32 v28, v28, s36, v31
  v_mul_f32 v28, v28, v24
  v_exp_f32 v28, v28
  v_mul_f32 v29, v25, v25
  v_fma_f32 v29, v29, s36, v31
  v_mul_f32 v29, v29, v25
  v_exp_f32 v29, v29
  s_nop 0
  v_add_f32 v26, 1.0, v26
  v_rcp_f32 v26, v26
  v_add_f32 v27, 1.0, v27
  v_rcp_f32 v27, v27
  v_add_f32 v28, 1.0, v28
  v_rcp_f32 v28, v28
  v_add_f32 v29, 1.0, v29
  v_rcp_f32 v29, v29
  s_nop 0
  v_mul_f32 v26, v26, v22
  v_sub_f32 v116, v22, v26
  v_mul_f32 v27, v27, v23
  v_sub_f32 v117, v23, v27
  v_mul_f32 v28, v28, v24
  v_sub_f32 v118, v24, v28
  v_mul_f32 v29, v29, v25
  v_sub_f32 v119, v25, v29
  v_cvt_pk_bf16_f32 v16, v116, v117
  v_cvt_pk_bf16_f32 v17, v118, v119
  ds_write_b64 v3, v[16:17] offset:80
  buffer_load_dwordx2 v[18:19], v15, s[56:59], 0 offen offset:96
  s_waitcnt vmcnt(0)
  v_cvt_pk_bf16_f32 v20, v120, v121
  v_cvt_pk_bf16_f32 v21, v122, v123
  v_lshlrev_b32 v22, 16, v20
  v_lshlrev_b32 v26, 16, v18
  v_and_b32 v23, 0xffff0000, v20
  v_and_b32 v27, 0xffff0000, v18
  v_lshlrev_b32 v24, 16, v21
  v_lshlrev_b32 v28, 16, v19
  v_and_b32 v25, 0xffff0000, v21
  v_and_b32 v29, 0xffff0000, v19
  v_add_f32 v22, v22, v26
  v_add_f32 v23, v23, v27
  v_add_f32 v24, v24, v28
  v_add_f32 v25, v25, v29
  v_cvt_pk_bf16_f32 v20, v22, v23
  v_cvt_pk_bf16_f32 v21, v24, v25
  v_lshlrev_b32 v22, 16, v20
  v_and_b32 v23, 0xffff0000, v20
  v_lshlrev_b32 v24, 16, v21
  v_and_b32 v25, 0xffff0000, v21
  v_mul_f32 v26, v22, v22
  v_fma_f32 v26, v26, s36, v31
  v_mul_f32 v26, v26, v22
  v_exp_f32 v26, v26
  v_mul_f32 v27, v23, v23
  v_fma_f32 v27, v27, s36, v31
  v_mul_f32 v27, v27, v23
  v_exp_f32 v27, v27
  v_mul_f32 v28, v24, v24
  v_fma_f32 v28, v28, s36, v31
  v_mul_f32 v28, v28, v24
  v_exp_f32 v28, v28
  v_mul_f32 v29, v25, v25
  v_fma_f32 v29, v29, s36, v31
  v_mul_f32 v29, v29, v25
  v_exp_f32 v29, v29
  s_nop 0
  v_add_f32 v26, 1.0, v26
  v_rcp_f32 v26, v26
  v_add_f32 v27, 1.0, v27
  v_rcp_f32 v27, v27
  v_add_f32 v28, 1.0, v28
  v_rcp_f32 v28, v28
  v_add_f32 v29, 1.0, v29
  v_rcp_f32 v29, v29
  s_nop 0
  v_mul_f32 v26, v26, v22
  v_sub_f32 v120, v22, v26
  v_mul_f32 v27, v27, v23
  v_sub_f32 v121, v23, v27
  v_mul_f32 v28, v28, v24
  v_sub_f32 v122, v24, v28
  v_mul_f32 v29, v29, v25
  v_sub_f32 v123, v25, v29
  v_cvt_pk_bf16_f32 v16, v120, v121
  v_cvt_pk_bf16_f32 v17, v122, v123
  ds_write_b64 v3, v[16:17] offset:96
  buffer_load_dwordx2 v[18:19], v15, s[56:59], 0 offen offset:112
  s_waitcnt vmcnt(0)
  v_cvt_pk_bf16_f32 v20, v124, v125
  v_cvt_pk_bf16_f32 v21, v126, v127
  v_lshlrev_b32 v22, 16, v20
  v_lshlrev_b32 v26, 16, v18
  v_and_b32 v23, 0xffff0000, v20
  v_and_b32 v27, 0xffff0000, v18
  v_lshlrev_b32 v24, 16, v21
  v_lshlrev_b32 v28, 16, v19
  v_and_b32 v25, 0xffff0000, v21
  v_and_b32 v29, 0xffff0000, v19
  v_add_f32 v22, v22, v26
  v_add_f32 v23, v23, v27
  v_add_f32 v24, v24, v28
  v_add_f32 v25, v25, v29
  v_cvt_pk_bf16_f32 v20, v22, v23
  v_cvt_pk_bf16_f32 v21, v24, v25
  v_lshlrev_b32 v22, 16, v20
  v_and_b32 v23, 0xffff0000, v20
  v_lshlrev_b32 v24, 16, v21
  v_and_b32 v25, 0xffff0000, v21
  v_mul_f32 v26, v22, v22
  v_fma_f32 v26, v26, s36, v31
  v_mul_f32 v26, v26, v22
  v_exp_f32 v26, v26
  v_mul_f32 v27, v23, v23
  v_fma_f32 v27, v27, s36, v31
  v_mul_f32 v27, v27, v23
  v_exp_f32 v27, v27
  v_mul_f32 v28, v24, v24
  v_fma_f32 v28, v28, s36, v31
  v_mul_f32 v28, v28, v24
  v_exp_f32 v28, v28
  v_mul_f32 v29, v25, v25
  v_fma_f32 v29, v29, s36, v31
  v_mul_f32 v29, v29, v25
  v_exp_f32 v29, v29
  s_nop 0
  v_add_f32 v26, 1.0, v26
  v_rcp_f32 v26, v26
  v_add_f32 v27, 1.0, v27
  v_rcp_f32 v27, v27
  v_add_f32 v28, 1.0, v28
  v_rcp_f32 v28, v28
  v_add_f32 v29, 1.0, v29
  v_rcp_f32 v29, v29
  s_nop 0
  v_mul_f32 v26, v26, v22
  v_sub_f32 v124, v22, v26
  v_mul_f32 v27, v27, v23
  v_sub_f32 v125, v23, v27
  v_mul_f32 v28, v28, v24
  v_sub_f32 v126, v24, v28
  v_mul_f32 v29, v29, v25
  v_sub_f32 v127, v25, v29
  v_cvt_pk_bf16_f32 v16, v124, v125
  v_cvt_pk_bf16_f32 v17, v126, v127
  ds_write_b64 v3, v[16:17] offset:112
  buffer_load_dwordx2 v[18:19], v15, s[56:59], 0 offen offset:64
  s_waitcnt vmcnt(0)
  v_cvt_pk_bf16_f32 v20, v128, v129
  v_cvt_pk_bf16_f32 v21, v130, v131
  v_lshlrev_b32 v22, 16, v20
  v_lshlrev_b32 v26, 16, v18
  v_and_b32 v23, 0xffff0000, v20
  v_and_b32 v27, 0xffff0000, v18
  v_lshlrev_b32 v24, 16, v21
  v_lshlrev_b32 v28, 16, v19
  v_and_b32 v25, 0xffff0000, v21
  v_and_b32 v29, 0xffff0000, v19
  v_add_f32 v22, v22, v26
  v_add_f32 v23, v23, v27
  v_add_f32 v24, v24, v28
  v_add_f32 v25, v25, v29
  v_cvt_pk_bf16_f32 v20, v22, v23
  v_cvt_pk_bf16_f32 v21, v24, v25
  v_lshlrev_b32 v22, 16, v20
  v_and_b32 v23, 0xffff0000, v20
  v_lshlrev_b32 v24, 16, v21
  v_and_b32 v25, 0xffff0000, v21
  v_mul_f32 v26, v22, v22
  v_fma_f32 v26, v26, s36, v31
  v_mul_f32 v26, v26, v22
  v_exp_f32 v26, v26
  v_mul_f32 v27, v23, v23
  v_fma_f32 v27, v27, s36, v31
  v_mul_f32 v27, v27, v23
  v_exp_f32 v27, v27
  v_mul_f32 v28, v24, v24
  v_fma_f32 v28, v28, s36, v31
  v_mul_f32 v28, v28, v24
  v_exp_f32 v28, v28
  v_mul_f32 v29, v25, v25
  v_fma_f32 v29, v29, s36, v31
  v_mul_f32 v29, v29, v25
  v_exp_f32 v29, v29
  s_nop 0
  v_add_f32 v26, 1.0, v26
  v_rcp_f32 v26, v26
  v_add_f32 v27, 1.0, v27
  v_rcp_f32 v27, v27
  v_add_f32 v28, 1.0, v28
  v_rcp_f32 v28, v28
  v_add_f32 v29, 1.0, v29
  v_rcp_f32 v29, v29
  s_nop 0
  v_mul_f32 v26, v26, v22
  v_sub_f32 v128, v22, v26
  v_mul_f32 v27, v27, v23
  v_sub_f32 v129, v23, v27
  v_mul_f32 v28, v28, v24
  v_sub_f32 v130, v24, v28
  v_mul_f32 v29, v29, v25
  v_sub_f32 v131, v25, v29
  v_cvt_pk_bf16_f32 v16, v128, v129
  v_cvt_pk_bf16_f32 v17, v130, v131
  ds_write_b64 v3, v[16:17] offset:8768
  buffer_load_dwordx2 v[18:19], v15, s[56:59], 0 offen offset:80
  s_waitcnt vmcnt(0)
  v_cvt_pk_bf16_f32 v20, v132, v133
  v_cvt_pk_bf16_f32 v21, v134, v135
  v_lshlrev_b32 v22, 16, v20
  v_lshlrev_b32 v26, 16, v18
  v_and_b32 v23, 0xffff0000, v20
  v_and_b32 v27, 0xffff0000, v18
  v_lshlrev_b32 v24, 16, v21
  v_lshlrev_b32 v28, 16, v19
  v_and_b32 v25, 0xffff0000, v21
  v_and_b32 v29, 0xffff0000, v19
  v_add_f32 v22, v22, v26
  v_add_f32 v23, v23, v27
  v_add_f32 v24, v24, v28
  v_add_f32 v25, v25, v29
  v_cvt_pk_bf16_f32 v20, v22, v23
  v_cvt_pk_bf16_f32 v21, v24, v25
  v_lshlrev_b32 v22, 16, v20
  v_and_b32 v23, 0xffff0000, v20
  v_lshlrev_b32 v24, 16, v21
  v_and_b32 v25, 0xffff0000, v21
  v_mul_f32 v26, v22, v22
  v_fma_f32 v26, v26, s36, v31
  v_mul_f32 v26, v26, v22
  v_exp_f32 v26, v26
  v_mul_f32 v27, v23, v23
  v_fma_f32 v27, v27, s36, v31
  v_mul_f32 v27, v27, v23
  v_exp_f32 v27, v27
  v_mul_f32 v28, v24, v24
  v_fma_f32 v28, v28, s36, v31
  v_mul_f32 v28, v28, v24
  v_exp_f32 v28, v28
  v_mul_f32 v29, v25, v25
  v_fma_f32 v29, v29, s36, v31
  v_mul_f32 v29, v29, v25
  v_exp_f32 v29, v29
  s_nop 0
  v_add_f32 v26, 1.0, v26
  v_rcp_f32 v26, v26
  v_add_f32 v27, 1.0, v27
  v_rcp_f32 v27, v27
  v_add_f32 v28, 1.0, v28
  v_rcp_f32 v28, v28
  v_add_f32 v29, 1.0, v29
  v_rcp_f32 v29, v29
  s_nop 0
  v_mul_f32 v26, v26, v22
  v_sub_f32 v132, v22, v26
  v_mul_f32 v27, v27, v23
  v_sub_f32 v133, v23, v27
  v_mul_f32 v28, v28, v24
  v_sub_f32 v134, v24, v28
  v_mul_f32 v29, v29, v25
  v_sub_f32 v135, v25, v29
  v_cvt_pk_bf16_f32 v16, v132, v133
  v_cvt_pk_bf16_f32 v17, v134, v135
  ds_write_b64 v3, v[16:17] offset:8784
  buffer_load_dwordx2 v[18:19], v15, s[56:59], 0 offen offset:96
  s_waitcnt vmcnt(0)
  v_cvt_pk_bf16_f32 v20, v136, v137
  v_cvt_pk_bf16_f32 v21, v138, v139
  v_lshlrev_b32 v22, 16, v20
  v_lshlrev_b32 v26, 16, v18
  v_and_b32 v23, 0xffff0000, v20
  v_and_b32 v27, 0xffff0000, v18
  v_lshlrev_b32 v24, 16, v21
  v_lshlrev_b32 v28, 16, v19
  v_and_b32 v25, 0xffff0000, v21
  v_and_b32 v29, 0xffff0000, v19
  v_add_f32 v22, v22, v26
  v_add_f32 v23, v23, v27
  v_add_f32 v24, v24, v28
  v_add_f32 v25, v25, v29
  v_cvt_pk_bf16_f32 v20, v22, v23
  v_cvt_pk_bf16_f32 v21, v24, v25
  v_lshlrev_b32 v22, 16, v20
  v_and_b32 v23, 0xffff0000, v20
  v_lshlrev_b32 v24, 16, v21
  v_and_b32 v25, 0xffff0000, v21
  v_mul_f32 v26, v22, v22
  v_fma_f32 v26, v26, s36, v31
  v_mul_f32 v26, v26, v22
  v_exp_f32 v26, v26
  v_mul_f32 v27, v23, v23
  v_fma_f32 v27, v27, s36, v31
  v_mul_f32 v27, v27, v23
  v_exp_f32 v27, v27
  v_mul_f32 v28, v24, v24
  v_fma_f32 v28, v28, s36, v31
  v_mul_f32 v28, v28, v24
  v_exp_f32 v28, v28
  v_mul_f32 v29, v25, v25
  v_fma_f32 v29, v29, s36, v31
  v_mul_f32 v29, v29, v25
  v_exp_f32 v29, v29
  s_nop 0
  v_add_f32 v26, 1.0, v26
  v_rcp_f32 v26, v26
  v_add_f32 v27, 1.0, v27
  v_rcp_f32 v27, v27
  v_add_f32 v28, 1.0, v28
  v_rcp_f32 v28, v28
  v_add_f32 v29, 1.0, v29
  v_rcp_f32 v29, v29
  s_nop 0
  v_mul_f32 v26, v26, v22
  v_sub_f32 v136, v22, v26
  v_mul_f32 v27, v27, v23
  v_sub_f32 v137, v23, v27
  v_mul_f32 v28, v28, v24
  v_sub_f32 v138, v24, v28
  v_mul_f32 v29, v29, v25
  v_sub_f32 v139, v25, v29
  v_cvt_pk_bf16_f32 v16, v136, v137
  v_cvt_pk_bf16_f32 v17, v138, v139
  ds_write_b64 v3, v[16:17] offset:8800
  buffer_load_dwordx2 v[18:19], v15, s[56:59], 0 offen offset:112
  s_waitcnt vmcnt(0)
  v_cvt_pk_bf16_f32 v20, v140, v141
  v_cvt_pk_bf16_f32 v21, v142, v143
  v_lshlrev_b32 v22, 16, v20
  v_lshlrev_b32 v26, 16, v18
  v_and_b32 v23, 0xffff0000, v20
  v_and_b32 v27, 0xffff0000, v18
  v_lshlrev_b32 v24, 16, v21
  v_lshlrev_b32 v28, 16, v19
  v_and_b32 v25, 0xffff0000, v21
  v_and_b32 v29, 0xffff0000, v19
  v_add_f32 v22, v22, v26
  v_add_f32 v23, v23, v27
  v_add_f32 v24, v24, v28
  v_add_f32 v25, v25, v29
  v_cvt_pk_bf16_f32 v20, v22, v23
  v_cvt_pk_bf16_f32 v21, v24, v25
  v_lshlrev_b32 v22, 16, v20
  v_and_b32 v23, 0xffff0000, v20
  v_lshlrev_b32 v24, 16, v21
  v_and_b32 v25, 0xffff0000, v21
  v_mul_f32 v26, v22, v22
  v_fma_f32 v26, v26, s36, v31
  v_mul_f32 v26, v26, v22
  v_exp_f32 v26, v26
  v_mul_f32 v27, v23, v23
  v_fma_f32 v27, v27, s36, v31
  v_mul_f32 v27, v27, v23
  v_exp_f32 v27, v27
  v_mul_f32 v28, v24, v24
  v_fma_f32 v28, v28, s36, v31
  v_mul_f32 v28, v28, v24
  v_exp_f32 v28, v28
  v_mul_f32 v29, v25, v25
  v_fma_f32 v29, v29, s36, v31
  v_mul_f32 v29, v29, v25
  v_exp_f32 v29, v29
  s_nop 0
  v_add_f32 v26, 1.0, v26
  v_rcp_f32 v26, v26
  v_add_f32 v27, 1.0, v27
  v_rcp_f32 v27, v27
  v_add_f32 v28, 1.0, v28
  v_rcp_f32 v28, v28
  v_add_f32 v29, 1.0, v29
  v_rcp_f32 v29, v29
  s_nop 0
  v_mul_f32 v26, v26, v22
  v_sub_f32 v140, v22, v26
  v_mul_f32 v27, v27, v23
  v_sub_f32 v141, v23, v27
  v_mul_f32 v28, v28, v24
  v_sub_f32 v142, v24, v28
  v_mul_f32 v29, v29, v25
  v_sub_f32 v143, v25, v29
  v_cvt_pk_bf16_f32 v16, v140, v141
  v_cvt_pk_bf16_f32 v17, v142, v143
  ds_write_b64 v3, v[16:17] offset:8816
  s_waitcnt lgkmcnt(0)
  s_barrier
  ds_read_b128 v[80:83], v4 offset:0
  ds_read_b128 v[84:87], v4 offset:4352
  ds_read_b128 v[88:91], v4 offset:8704
  ds_read_b128 v[92:95], v4 offset:13056
  ds_read_b128 v[96:99], v4 offset:17408
  ds_read_b128 v[100:103], v4 offset:21760
  ds_read_b128 v[104:107], v4 offset:26112
  ds_read_b128 v[108:111], v4 offset:30464
  s_mov_b32 s23, 0
  s_waitcnt lgkmcnt(7)
  buffer_store_dwordx4 v[80:83], v5, s[12:15], s23 offen
  s_mov_b32 s23, 45056
  s_waitcnt lgkmcnt(6)
  buffer_store_dwordx4 v[84:87], v5, s[12:15], s23 offen
  s_mov_b32 s23, 90112
  s_waitcnt lgkmcnt(5)
  buffer_store_dwordx4 v[88:91], v5, s[12:15], s23 offen
  s_mov_b32 s23, 135168
  s_waitcnt lgkmcnt(4)
  buffer_store_dwordx4 v[92:95], v5, s[12:15], s23 offen
  s_mov_b32 s23, 180224
  s_waitcnt lgkmcnt(3)
  buffer_store_dwordx4 v[96:99], v5, s[12:15], s23 offen
  s_mov_b32 s23, 225280
  s_waitcnt lgkmcnt(2)
  buffer_store_dwordx4 v[100:103], v5, s[12:15], s23 offen
  s_mov_b32 s23, 270336
  s_waitcnt lgkmcnt(1)
  buffer_store_dwordx4 v[104:107], v5, s[12:15], s23 offen
  s_mov_b32 s23, 315392
  s_waitcnt lgkmcnt(0)
  buffer_store_dwordx4 v[108:111], v5, s[12:15], s23 offen
L_ffn1_kernel_done:
  s_endpgm
.section .rodata,"a"
.p2align 6
.amdhsa_kernel ffn1_kernel
  .amdhsa_next_free_vgpr 152
  .amdhsa_next_free_sgpr 96
  .amdhsa_accum_offset 152
  .amdhsa_group_segment_fixed_size 0
  .amdhsa_kernarg_size 112
  .amdhsa_user_sgpr_count 2
  .amdhsa_user_sgpr_kernarg_segment_ptr 1
  .amdhsa_system_sgpr_workgroup_id_x 1
.end_amdhsa_kernel
.text
.globl ffn2_kernel
.p2align 8
.type ffn2_kernel,@function
ffn2_kernel:
  s_cmp_ge_u32 s2, 64
  s_cbranch_scc1 L_ffn2_kernel_done
  s_load_dwordx4 s[32:35], s[0:1], 72
  s_load_dwordx2 s[40:41], s[0:1], 104
  s_load_dwordx2 s[48:49], s[0:1], 88
  s_and_b32 s16, s2, 3
  s_lshr_b32 s17, s2, 2
  s_waitcnt lgkmcnt(0)
  s_mul_i32 s19, s17, 360448
  s_add_u32 s19, s19, 90177536
  s_add_u32 s44, s40, s19
  s_addc_u32 s45, s41, 0

  s_mov_b32 s4, s44
  s_and_b32 s5, s45, 0xffff
  s_mov_b32 s6, 360448
  s_mov_b32 s7, 0x00020000
  s_lshl_b32 s19, s16, 8
  s_add_u32 s46, s32, s19
  s_addc_u32 s47, s33, 0
  s_sub_u32 s20, 1409024, s19

  s_mov_b32 s8, s46
  s_and_b32 s9, s47, 0xffff
  s_mov_b32 s10, s20
  s_mov_b32 s11, 0x00020000
  s_add_u32 s46, s34, s19
  s_addc_u32 s47, s35, 0

  s_mov_b32 s56, s46
  s_and_b32 s57, s47, 0xffff
  s_mov_b32 s58, 256
  s_mov_b32 s59, 0x00020000
  s_lshl_b32 s20, s17, 17
  s_add_u32 s20, s20, s19
  s_add_u32 s44, s48, s20
  s_addc_u32 s45, s49, 0

  s_mov_b32 s12, s44
  s_and_b32 s13, s45, 0xffff
  s_mov_b32 s14, 131072
  s_mov_b32 s15, 0x00020000
  s_add_u32 s20, s20, 85983232
  s_add_u32 s44, s40, s20
  s_addc_u32 s45, s41, 0

  s_mov_b32 s64, s44
  s_and_b32 s65, s45, 0xffff
  s_mov_b32 s66, 131072
  s_mov_b32 s67, 0x00020000
  v_and_b32 v1, 63, v0
  v_lshrrev_b32 v2, 6, v0
  s_nop 1
  v_readfirstlane_b32 s50, v2
  v_lshrrev_b32 v5, 3, v1
  v_and_b32 v6, 7, v1
  v_lshrrev_b32 v7, 4, v1
  v_and_b32 v8, 1, v2
  v_lshl_add_u32 v8, v8, 2, v7
  v_xor_b32 v6, v6, v8
  v_mul_u32_u24 v3, 2816, v5
  v_lshl_add_u32 v3, v6, 4, v3
  v_and_b32 v6, 15, v1
  v_lshlrev_b32 v8, 2, v7
  v_xor_b32 v6, v6, v8
  v_mul_u32_u24 v4, 1024, v7
  v_lshl_add_u32 v4, v6, 4, v4

  v_and_b32 v1, 63, v0
  v_lshrrev_b32 v2, 6, v0
  v_lshrrev_b32 v7, 1, v2
  v_and_b32 v2, 1, v2
  v_and_b32 v8, 31, v1
  v_lshl_add_u32 v8, v7, 6, v8
  v_lshlrev_b32 v8, 7, v8
  v_lshrrev_b32 v9, 1, v1
  v_and_b32 v9, 7, v9
  v_lshrrev_b32 v10, 5, v1

  v_add_u32 v11, 0, v10
  v_xor_b32 v11, v11, v9
  v_lshl_add_u32 v12, v11, 4, v8

  v_add_u32 v11, 2, v10
  v_xor_b32 v11, v11, v9
  v_lshl_add_u32 v13, v11, 4, v8

  v_add_u32 v11, 4, v10
  v_xor_b32 v11, v11, v9
  v_lshl_add_u32 v14, v11, 4, v8

  v_add_u32 v11, 6, v10
  v_xor_b32 v11, v11, v9
  v_lshl_add_u32 v15, v11, 4, v8

  v_and_b32 v8, 15, v1
  v_lshrrev_b32 v9, 2, v8
  v_and_b32 v8, 3, v8
  v_lshrrev_b32 v7, 4, v1
  v_lshrrev_b32 v10, 1, v7
  v_lshlrev_b32 v10, 3, v10
  v_add_u32 v10, v10, v9
  v_lshlrev_b32 v10, 8, v10
  v_and_b32 v7, 1, v7
  v_lshlrev_b32 v7, 1, v7
  v_lshrrev_b32 v11, 1, v8
  v_add_u32 v7, v7, v11
  v_lshl_add_u32 v7, v2, 3, v7
  v_lshlrev_b32 v9, 2, v9
  v_and_b32 v8, 1, v8
  v_lshlrev_b32 v8, 3, v8
  v_add_u32 v10, v10, v8
  v_add_u32 v10, 16384, v10
  v_xor_b32 v11, v7, v9
  v_lshl_add_u32 v1, v11, 4, v10
  v_add_u32 v7, 4, v7
  v_xor_b32 v11, v7, v9
  v_lshl_add_u32 v2, v11, 4, v10
  v_mov_b32 v10, v1
  v_mov_b32 v11, v2

  v_add_u32 v144, 0x10000, v12
  v_add_u32 v145, 0x10000, v13
  v_add_u32 v146, 0x10000, v14
  v_add_u32 v147, 0x10000, v15
  v_add_u32 v148, 0x10000, v10
  v_add_u32 v149, 0x10000, v11
  v_mov_b32 v80, 0
  v_mov_b32 v81, 0
  v_mov_b32 v82, 0
  v_mov_b32 v83, 0
  v_mov_b32 v84, 0
  v_mov_b32 v85, 0
  v_mov_b32 v86, 0
  v_mov_b32 v87, 0
  v_mov_b32 v88, 0
  v_mov_b32 v89, 0
  v_mov_b32 v90, 0
  v_mov_b32 v91, 0
  v_mov_b32 v92, 0
  v_mov_b32 v93, 0
  v_mov_b32 v94, 0
  v_mov_b32 v95, 0
  v_mov_b32 v96, 0
  v_mov_b32 v97, 0
  v_mov_b32 v98, 0
  v_mov_b32 v99, 0
  v_mov_b32 v100, 0
  v_mov_b32 v101, 0
  v_mov_b32 v102, 0
  v_mov_b32 v103, 0
  v_mov_b32 v104, 0
  v_mov_b32 v105, 0
  v_mov_b32 v106, 0
  v_mov_b32 v107, 0
  v_mov_b32 v108, 0
  v_mov_b32 v109, 0
  v_mov_b32 v110, 0
  v_mov_b32 v111, 0
  v_mov_b32 v112, 0
  v_mov_b32 v113, 0
  v_mov_b32 v114, 0
  v_mov_b32 v115, 0
  v_mov_b32 v116, 0
  v_mov_b32 v117, 0
  v_mov_b32 v118, 0
  v_mov_b32 v119, 0
  v_mov_b32 v120, 0
  v_mov_b32 v121, 0
  v_mov_b32 v122, 0
  v_mov_b32 v123, 0
  v_mov_b32 v124, 0
  v_mov_b32 v125, 0
  v_mov_b32 v126, 0
  v_mov_b32 v127, 0
  v_mov_b32 v128, 0
  v_mov_b32 v129, 0
  v_mov_b32 v130, 0
  v_mov_b32 v131, 0
  v_mov_b32 v132, 0
  v_mov_b32 v133, 0
  v_mov_b32 v134, 0
  v_mov_b32 v135, 0
  v_mov_b32 v136, 0
  v_mov_b32 v137, 0
  v_mov_b32 v138, 0
  v_mov_b32 v139, 0
  v_mov_b32 v140, 0
  v_mov_b32 v141, 0
  v_mov_b32 v142, 0
  v_mov_b32 v143, 0
  s_mul_i32 s51, s50, 22528
  s_mul_i32 s52, s50, 4096
  s_add_u32 s24, s51, 0
  s_add_u32 s28, s52, 0
  s_add_u32 s25, s51, 90112
  s_add_u32 s29, s52, 16384
  s_add_u32 s26, s51, 180224
  s_add_u32 s30, s52, 32768
  s_add_u32 s27, s51, 270336
  s_add_u32 s31, s52, 49152
  s_lshl_b32 s53, s50, 10
  s_add_u32 m0, s53, 0
  s_nop 0
  buffer_load_dwordx4 v3, s[4:7], s24 offen lds
  s_add_u32 m0, s53, 4096
  s_nop 0
  buffer_load_dwordx4 v3, s[4:7], s25 offen lds
  s_add_u32 m0, s53, 8192
  s_nop 0
  buffer_load_dwordx4 v3, s[4:7], s26 offen lds
  s_add_u32 m0, s53, 12288
  s_nop 0
  buffer_load_dwordx4 v3, s[4:7], s27 offen lds
  s_add_u32 m0, s53, 16384
  s_nop 0
  buffer_load_dwordx4 v4, s[8:11], s28 offen lds
  s_add_u32 m0, s53, 20480
  s_nop 0
  buffer_load_dwordx4 v4, s[8:11], s29 offen lds
  s_add_u32 m0, s53, 24576
  s_nop 0
  buffer_load_dwordx4 v4, s[8:11], s30 offen lds
  s_add_u32 m0, s53, 28672
  s_nop 0
  buffer_load_dwordx4 v4, s[8:11], s31 offen lds
  s_add_u32 s24, s24, 128
  s_add_u32 s28, s28, 65536
  s_add_u32 s25, s25, 128
  s_add_u32 s29, s29, 65536
  s_add_u32 s26, s26, 128
  s_add_u32 s30, s30, 65536
  s_add_u32 s27, s27, 128
  s_add_u32 s31, s31, 65536
  s_add_u32 m0, s53, 32768
  s_nop 0
  buffer_load_dwordx4 v3, s[4:7], s24 offen lds
  s_add_u32 m0, s53, 36864
  s_nop 0
  buffer_load_dwordx4 v3, s[4:7], s25 offen lds
  s_add_u32 m0, s53, 40960
  s_nop 0
  buffer_load_dwordx4 v3, s[4:7], s26 offen lds
  s_add_u32 m0, s53, 45056
  s_nop 0
  buffer_load_dwordx4 v3, s[4:7], s27 offen lds
  s_add_u32 m0, s53, 49152
  s_nop 0
  buffer_load_dwordx4 v4, s[8:11], s28 offen lds
  s_add_u32 m0, s53, 53248
  s_nop 0
  buffer_load_dwordx4 v4, s[8:11], s29 offen lds
  s_add_u32 m0, s53, 57344
  s_nop 0
  buffer_load_dwordx4 v4, s[8:11], s30 offen lds
  s_add_u32 m0, s53, 61440
  s_nop 0
  buffer_load_dwordx4 v4, s[8:11], s31 offen lds
  s_add_u32 s24, s24, 128
  s_add_u32 s28, s28, 65536
  s_add_u32 s25, s25, 128
  s_add_u32 s29, s29, 65536
  s_add_u32 s26, s26, 128
  s_add_u32 s30, s30, 65536
  s_add_u32 s27, s27, 128
  s_add_u32 s31, s31, 65536
  s_add_u32 m0, s53, 65536
  s_nop 0
  buffer_load_dwordx4 v3, s[4:7], s24 offen lds
  s_add_u32 m0, s53, 69632
  s_nop 0
  buffer_load_dwordx4 v3, s[4:7], s25 offen lds
  s_add_u32 m0, s53, 73728
  s_nop 0
  buffer_load_dwordx4 v3, s[4:7], s26 offen lds
  s_add_u32 m0, s53, 77824
  s_nop 0
  buffer_load_dwordx4 v3, s[4:7], s27 offen lds
  s_add_u32 m0, s53, 81920
  s_nop 0
  buffer_load_dwordx4 v4, s[8:11], s28 offen lds
  s_add_u32 m0, s53, 86016
  s_nop 0
  buffer_load_dwordx4 v4, s[8:11], s29 offen lds
  s_add_u32 m0, s53, 90112
  s_nop 0
  buffer_load_dwordx4 v4, s[8:11], s30 offen lds
  s_add_u32 m0, s53, 94208
  s_nop 0
  buffer_load_dwordx4 v4, s[8:11], s31 offen lds
  s_add_u32 s24, s24, 128
  s_add_u32 s28, s28, 65536
  s_add_u32 s25, s25, 128
  s_add_u32 s29, s29, 65536
  s_add_u32 s26, s26, 128
  s_add_u32 s30, s30, 65536
  s_add_u32 s27, s27, 128
  s_add_u32 s31, s31, 65536
  s_mov_b32 s22, 6
L_ffn2_kernel_loop:
  s_waitcnt vmcnt(16)
  s_barrier
  s_add_u32 m0, s53, 98304
  s_nop 0
  buffer_load_dwordx4 v3, s[4:7], s24 offen lds
  s_add_u32 m0, s53, 102400
  s_nop 0
  buffer_load_dwordx4 v3, s[4:7], s25 offen lds
  s_add_u32 m0, s53, 106496
  s_nop 0
  buffer_load_dwordx4 v3, s[4:7], s26 offen lds
  s_add_u32 m0, s53, 110592
  s_nop 0
  buffer_load_dwordx4 v3, s[4:7], s27 offen lds
  s_add_u32 m0, s53, 114688
  s_nop 0
  buffer_load_dwordx4 v4, s[8:11], s28 offen lds
  s_add_u32 m0, s53, 118784
  s_nop 0
  buffer_load_dwordx4 v4, s[8:11], s29 offen lds
  s_add_u32 m0, s53, 122880
  s_nop 0
  buffer_load_dwordx4 v4, s[8:11], s30 offen lds
  s_add_u32 m0, s53, 126976
  s_nop 0
  buffer_load_dwordx4 v4, s[8:11], s31 offen lds
  s_add_u32 s24, s24, 128
  s_add_u32 s28, s28, 65536
  s_add_u32 s25, s25, 128
  s_add_u32 s29, s29, 65536
  s_add_u32 s26, s26, 128
  s_add_u32 s30, s30, 65536
  s_add_u32 s27, s27, 128
  s_add_u32 s31, s31, 65536
  ds_read_b128 v[48:51], v12 offset:0
  ds_read_b128 v[52:55], v12 offset:4096
  ds_read_b64_tr_b16 v[56:57], v10 offset:0
  ds_read_b64_tr_b16 v[58:59], v10 offset:1024
  ds_read_b64_tr_b16 v[60:61], v11 offset:0
  ds_read_b64_tr_b16 v[62:63], v11 offset:1024
  ds_read_b128 v[64:67], v13 offset:0
  ds_read_b128 v[68:71], v13 offset:4096
  ds_read_b64_tr_b16 v[72:73], v10 offset:4096
  ds_read_b64_tr_b16 v[74:75], v10 offset:5120
  ds_read_b64_tr_b16 v[76:77], v11 offset:4096
  ds_read_b64_tr_b16 v[78:79], v11 offset:5120
  s_waitcnt lgkmcnt(6)
  v_mfma_f32_32x32x16_bf16 v[80:95], v[56:59], v[48:51], v[80:95]
  v_mfma_f32_32x32x16_bf16 v[96:111], v[56:59], v[52:55], v[96:111]
  v_mfma_f32_32x32x16_bf16 v[112:127], v[60:63], v[48:51], v[112:127]
  v_mfma_f32_32x32x16_bf16 v[128:143], v[60:63], v[52:55], v[128:143]
  ds_read_b128 v[48:51], v14 offset:0
  ds_read_b128 v[52:55], v14 offset:4096
  ds_read_b64_tr_b16 v[56:57], v10 offset:8192
  ds_read_b64_tr_b16 v[58:59], v10 offset:9216
  ds_read_b64_tr_b16 v[60:61], v11 offset:8192
  ds_read_b64_tr_b16 v[62:63], v11 offset:9216
  s_waitcnt lgkmcnt(6)
  v_mfma_f32_32x32x16_bf16 v[80:95], v[72:75], v[64:67], v[80:95]
  v_mfma_f32_32x32x16_bf16 v[96:111], v[72:75], v[68:71], v[96:111]
  v_mfma_f32_32x32x16_bf16 v[112:127], v[76:79], v[64:67], v[112:127]
  v_mfma_f32_32x32x16_bf16 v[128:143], v[76:79], v[68:71], v[128:143]
  ds_read_b128 v[64:67], v15 offset:0
  ds_read_b128 v[68:71], v15 offset:4096
  ds_read_b64_tr_b16 v[72:73], v10 offset:12288
  ds_read_b64_tr_b16 v[74:75], v10 offset:13312
  ds_read_b64_tr_b16 v[76:77], v11 offset:12288
  ds_read_b64_tr_b16 v[78:79], v11 offset:13312
  s_waitcnt lgkmcnt(6)
  v_mfma_f32_32x32x16_bf16 v[80:95], v[56:59], v[48:51], v[80:95]
  v_mfma_f32_32x32x16_bf16 v[96:111], v[56:59], v[52:55], v[96:111]
  v_mfma_f32_32x32x16_bf16 v[112:127], v[60:63], v[48:51], v[112:127]
  v_mfma_f32_32x32x16_bf16 v[128:143], v[60:63], v[52:55], v[128:143]
  s_waitcnt lgkmcnt(0)
  v_mfma_f32_32x32x16_bf16 v[80:95], v[72:75], v[64:67], v[80:95]
  v_mfma_f32_32x32x16_bf16 v[96:111], v[72:75], v[68:71], v[96:111]
  v_mfma_f32_32x32x16_bf16 v[112:127], v[76:79], v[64:67], v[112:127]
  v_mfma_f32_32x32x16_bf16 v[128:143], v[76:79], v[68:71], v[128:143]
  s_waitcnt vmcnt(16)
  s_barrier
  s_add_u32 m0, s53, 0
  s_nop 0
  buffer_load_dwordx4 v3, s[4:7], s24 offen lds
  s_add_u32 m0, s53, 4096
  s_nop 0
  buffer_load_dwordx4 v3, s[4:7], s25 offen lds
  s_add_u32 m0, s53, 8192
  s_nop 0
  buffer_load_dwordx4 v3, s[4:7], s26 offen lds
  s_add_u32 m0, s53, 12288
  s_nop 0
  buffer_load_dwordx4 v3, s[4:7], s27 offen lds
  s_add_u32 m0, s53, 16384
  s_nop 0
  buffer_load_dwordx4 v4, s[8:11], s28 offen lds
  s_add_u32 m0, s53, 20480
  s_nop 0
  buffer_load_dwordx4 v4, s[8:11], s29 offen lds
  s_add_u32 m0, s53, 24576
  s_nop 0
  buffer_load_dwordx4 v4, s[8:11], s30 offen lds
  s_add_u32 m0, s53, 28672
  s_nop 0
  buffer_load_dwordx4 v4, s[8:11], s31 offen lds
  s_add_u32 s24, s24, 128
  s_add_u32 s28, s28, 65536
  s_add_u32 s25, s25, 128
  s_add_u32 s29, s29, 65536
  s_add_u32 s26, s26, 128
  s_add_u32 s30, s30, 65536
  s_add_u32 s27, s27, 128
  s_add_u32 s31, s31, 65536
  ds_read_b128 v[48:51], v12 offset:32768
  ds_read_b128 v[52:55], v12 offset:36864
  ds_read_b64_tr_b16 v[56:57], v10 offset:32768
  ds_read_b64_tr_b16 v[58:59], v10 offset:33792
  ds_read_b64_tr_b16 v[60:61], v11 offset:32768
  ds_read_b64_tr_b16 v[62:63], v11 offset:33792
  ds_read_b128 v[64:67], v13 offset:32768
  ds_read_b128 v[68:71], v13 offset:36864
  ds_read_b64_tr_b16 v[72:73], v10 offset:36864
  ds_read_b64_tr_b16 v[74:75], v10 offset:37888
  ds_read_b64_tr_b16 v[76:77], v11 offset:36864
  ds_read_b64_tr_b16 v[78:79], v11 offset:37888
  s_waitcnt lgkmcnt(6)
  v_mfma_f32_32x32x16_bf16 v[80:95], v[56:59], v[48:51], v[80:95]
  v_mfma_f32_32x32x16_bf16 v[96:111], v[56:59], v[52:55], v[96:111]
  v_mfma_f32_32x32x16_bf16 v[112:127], v[60:63], v[48:51], v[112:127]
  v_mfma_f32_32x32x16_bf16 v[128:143], v[60:63], v[52:55], v[128:143]
  ds_read_b128 v[48:51], v14 offset:32768
  ds_read_b128 v[52:55], v14 offset:36864
  ds_read_b64_tr_b16 v[56:57], v10 offset:40960
  ds_read_b64_tr_b16 v[58:59], v10 offset:41984
  ds_read_b64_tr_b16 v[60:61], v11 offset:40960
  ds_read_b64_tr_b16 v[62:63], v11 offset:41984
  s_waitcnt lgkmcnt(6)
  v_mfma_f32_32x32x16_bf16 v[80:95], v[72:75], v[64:67], v[80:95]
  v_mfma_f32_32x32x16_bf16 v[96:111], v[72:75], v[68:71], v[96:111]
  v_mfma_f32_32x32x16_bf16 v[112:127], v[76:79], v[64:67], v[112:127]
  v_mfma_f32_32x32x16_bf16 v[128:143], v[76:79], v[68:71], v[128:143]
  ds_read_b128 v[64:67], v15 offset:32768
  ds_read_b128 v[68:71], v15 offset:36864
  ds_read_b64_tr_b16 v[72:73], v10 offset:45056
  ds_read_b64_tr_b16 v[74:75], v10 offset:46080
  ds_read_b64_tr_b16 v[76:77], v11 offset:45056
  ds_read_b64_tr_b16 v[78:79], v11 offset:46080
  s_waitcnt lgkmcnt(6)
  v_mfma_f32_32x32x16_bf16 v[80:95], v[56:59], v[48:51], v[80:95]
  v_mfma_f32_32x32x16_bf16 v[96:111], v[56:59], v[52:55], v[96:111]
  v_mfma_f32_32x32x16_bf16 v[112:127], v[60:63], v[48:51], v[112:127]
  v_mfma_f32_32x32x16_bf16 v[128:143], v[60:63], v[52:55], v[128:143]
  s_waitcnt lgkmcnt(0)
  v_mfma_f32_32x32x16_bf16 v[80:95], v[72:75], v[64:67], v[80:95]
  v_mfma_f32_32x32x16_bf16 v[96:111], v[72:75], v[68:71], v[96:111]
  v_mfma_f32_32x32x16_bf16 v[112:127], v[76:79], v[64:67], v[112:127]
  v_mfma_f32_32x32x16_bf16 v[128:143], v[76:79], v[68:71], v[128:143]
  s_waitcnt vmcnt(16)
  s_barrier
  s_add_u32 m0, s53, 32768
  s_nop 0
  buffer_load_dwordx4 v3, s[4:7], s24 offen lds
  s_add_u32 m0, s53, 36864
  s_nop 0
  buffer_load_dwordx4 v3, s[4:7], s25 offen lds
  s_add_u32 m0, s53, 40960
  s_nop 0
  buffer_load_dwordx4 v3, s[4:7], s26 offen lds
  s_add_u32 m0, s53, 45056
  s_nop 0
  buffer_load_dwordx4 v3, s[4:7], s27 offen lds
  s_add_u32 m0, s53, 49152
  s_nop 0
  buffer_load_dwordx4 v4, s[8:11], s28 offen lds
  s_add_u32 m0, s53, 53248
  s_nop 0
  buffer_load_dwordx4 v4, s[8:11], s29 offen lds
  s_add_u32 m0, s53, 57344
  s_nop 0
  buffer_load_dwordx4 v4, s[8:11], s30 offen lds
  s_add_u32 m0, s53, 61440
  s_nop 0
  buffer_load_dwordx4 v4, s[8:11], s31 offen lds
  s_add_u32 s24, s24, 128
  s_add_u32 s28, s28, 65536
  s_add_u32 s25, s25, 128
  s_add_u32 s29, s29, 65536
  s_add_u32 s26, s26, 128
  s_add_u32 s30, s30, 65536
  s_add_u32 s27, s27, 128
  s_add_u32 s31, s31, 65536
  ds_read_b128 v[48:51], v144 offset:0
  ds_read_b128 v[52:55], v144 offset:4096
  ds_read_b64_tr_b16 v[56:57], v148 offset:0
  ds_read_b64_tr_b16 v[58:59], v148 offset:1024
  ds_read_b64_tr_b16 v[60:61], v149 offset:0
  ds_read_b64_tr_b16 v[62:63], v149 offset:1024
  ds_read_b128 v[64:67], v145 offset:0
  ds_read_b128 v[68:71], v145 offset:4096
  ds_read_b64_tr_b16 v[72:73], v148 offset:4096
  ds_read_b64_tr_b16 v[74:75], v148 offset:5120
  ds_read_b64_tr_b16 v[76:77], v149 offset:4096
  ds_read_b64_tr_b16 v[78:79], v149 offset:5120
  s_waitcnt lgkmcnt(6)
  v_mfma_f32_32x32x16_bf16 v[80:95], v[56:59], v[48:51], v[80:95]
  v_mfma_f32_32x32x16_bf16 v[96:111], v[56:59], v[52:55], v[96:111]
  v_mfma_f32_32x32x16_bf16 v[112:127], v[60:63], v[48:51], v[112:127]
  v_mfma_f32_32x32x16_bf16 v[128:143], v[60:63], v[52:55], v[128:143]
  ds_read_b128 v[48:51], v146 offset:0
  ds_read_b128 v[52:55], v146 offset:4096
  ds_read_b64_tr_b16 v[56:57], v148 offset:8192
  ds_read_b64_tr_b16 v[58:59], v148 offset:9216
  ds_read_b64_tr_b16 v[60:61], v149 offset:8192
  ds_read_b64_tr_b16 v[62:63], v149 offset:9216
  s_waitcnt lgkmcnt(6)
  v_mfma_f32_32x32x16_bf16 v[80:95], v[72:75], v[64:67], v[80:95]
  v_mfma_f32_32x32x16_bf16 v[96:111], v[72:75], v[68:71], v[96:111]
  v_mfma_f32_32x32x16_bf16 v[112:127], v[76:79], v[64:67], v[112:127]
  v_mfma_f32_32x32x16_bf16 v[128:143], v[76:79], v[68:71], v[128:143]
  ds_read_b128 v[64:67], v147 offset:0
  ds_read_b128 v[68:71], v147 offset:4096
  ds_read_b64_tr_b16 v[72:73], v148 offset:12288
  ds_read_b64_tr_b16 v[74:75], v148 offset:13312
  ds_read_b64_tr_b16 v[76:77], v149 offset:12288
  ds_read_b64_tr_b16 v[78:79], v149 offset:13312
  s_waitcnt lgkmcnt(6)
  v_mfma_f32_32x32x16_bf16 v[80:95], v[56:59], v[48:51], v[80:95]
  v_mfma_f32_32x32x16_bf16 v[96:111], v[56:59], v[52:55], v[96:111]
  v_mfma_f32_32x32x16_bf16 v[112:127], v[60:63], v[48:51], v[112:127]
  v_mfma_f32_32x32x16_bf16 v[128:143], v[60:63], v[52:55], v[128:143]
  s_waitcnt lgkmcnt(0)
  v_mfma_f32_32x32x16_bf16 v[80:95], v[72:75], v[64:67], v[80:95]
  v_mfma_f32_32x32x16_bf16 v[96:111], v[72:75], v[68:71], v[96:111]
  v_mfma_f32_32x32x16_bf16 v[112:127], v[76:79], v[64:67], v[112:127]
  v_mfma_f32_32x32x16_bf16 v[128:143], v[76:79], v[68:71], v[128:143]
  s_waitcnt vmcnt(16)
  s_barrier
  s_add_u32 m0, s53, 65536
  s_nop 0
  buffer_load_dwordx4 v3, s[4:7], s24 offen lds
  s_add_u32 m0, s53, 69632
  s_nop 0
  buffer_load_dwordx4 v3, s[4:7], s25 offen lds
  s_add_u32 m0, s53, 73728
  s_nop 0
  buffer_load_dwordx4 v3, s[4:7], s26 offen lds
  s_add_u32 m0, s53, 77824
  s_nop 0
  buffer_load_dwordx4 v3, s[4:7], s27 offen lds
  s_add_u32 m0, s53, 81920
  s_nop 0
  buffer_load_dwordx4 v4, s[8:11], s28 offen lds
  s_add_u32 m0, s53, 86016
  s_nop 0
  buffer_load_dwordx4 v4, s[8:11], s29 offen lds
  s_add_u32 m0, s53, 90112
  s_nop 0
  buffer_load_dwordx4 v4, s[8:11], s30 offen lds
  s_add_u32 m0, s53, 94208
  s_nop 0
  buffer_load_dwordx4 v4, s[8:11], s31 offen lds
  s_add_u32 s24, s24, 128
  s_add_u32 s28, s28, 65536
  s_add_u32 s25, s25, 128
  s_add_u32 s29, s29, 65536
  s_add_u32 s26, s26, 128
  s_add_u32 s30, s30, 65536
  s_add_u32 s27, s27, 128
  s_add_u32 s31, s31, 65536
  ds_read_b128 v[48:51], v144 offset:32768
  ds_read_b128 v[52:55], v144 offset:36864
  ds_read_b64_tr_b16 v[56:57], v148 offset:32768
  ds_read_b64_tr_b16 v[58:59], v148 offset:33792
  ds_read_b64_tr_b16 v[60:61], v149 offset:32768
  ds_read_b64_tr_b16 v[62:63], v149 offset:33792
  ds_read_b128 v[64:67], v145 offset:32768
  ds_read_b128 v[68:71], v145 offset:36864
  ds_read_b64_tr_b16 v[72:73], v148 offset:36864
  ds_read_b64_tr_b16 v[74:75], v148 offset:37888
  ds_read_b64_tr_b16 v[76:77], v149 offset:36864
  ds_read_b64_tr_b16 v[78:79], v149 offset:37888
  s_waitcnt lgkmcnt(6)
  v_mfma_f32_32x32x16_bf16 v[80:95], v[56:59], v[48:51], v[80:95]
  v_mfma_f32_32x32x16_bf16 v[96:111], v[56:59], v[52:55], v[96:111]
  v_mfma_f32_32x32x16_bf16 v[112:127], v[60:63], v[48:51], v[112:127]
  v_mfma_f32_32x32x16_bf16 v[128:143], v[60:63], v[52:55], v[128:143]
  ds_read_b128 v[48:51], v146 offset:32768
  ds_read_b128 v[52:55], v146 offset:36864
  ds_read_b64_tr_b16 v[56:57], v148 offset:40960
  ds_read_b64_tr_b16 v[58:59], v148 offset:41984
  ds_read_b64_tr_b16 v[60:61], v149 offset:40960
  ds_read_b64_tr_b16 v[62:63], v149 offset:41984
  s_waitcnt lgkmcnt(6)
  v_mfma_f32_32x32x16_bf16 v[80:95], v[72:75], v[64:67], v[80:95]
  v_mfma_f32_32x32x16_bf16 v[96:111], v[72:75], v[68:71], v[96:111]
  v_mfma_f32_32x32x16_bf16 v[112:127], v[76:79], v[64:67], v[112:127]
  v_mfma_f32_32x32x16_bf16 v[128:143], v[76:79], v[68:71], v[128:143]
  ds_read_b128 v[64:67], v147 offset:32768
  ds_read_b128 v[68:71], v147 offset:36864
  ds_read_b64_tr_b16 v[72:73], v148 offset:45056
  ds_read_b64_tr_b16 v[74:75], v148 offset:46080
  ds_read_b64_tr_b16 v[76:77], v149 offset:45056
  ds_read_b64_tr_b16 v[78:79], v149 offset:46080
  s_waitcnt lgkmcnt(6)
  v_mfma_f32_32x32x16_bf16 v[80:95], v[56:59], v[48:51], v[80:95]
  v_mfma_f32_32x32x16_bf16 v[96:111], v[56:59], v[52:55], v[96:111]
  v_mfma_f32_32x32x16_bf16 v[112:127], v[60:63], v[48:51], v[112:127]
  v_mfma_f32_32x32x16_bf16 v[128:143], v[60:63], v[52:55], v[128:143]
  s_waitcnt lgkmcnt(0)
  v_mfma_f32_32x32x16_bf16 v[80:95], v[72:75], v[64:67], v[80:95]
  v_mfma_f32_32x32x16_bf16 v[96:111], v[72:75], v[68:71], v[96:111]
  v_mfma_f32_32x32x16_bf16 v[112:127], v[76:79], v[64:67], v[112:127]
  v_mfma_f32_32x32x16_bf16 v[128:143], v[76:79], v[68:71], v[128:143]
  s_sub_u32 s22, s22, 1
  s_cmp_lg_u32 s22, 0
  s_cbranch_scc1 L_ffn2_kernel_loop
  s_waitcnt vmcnt(0)
  s_barrier
  s_nop 7
  s_nop 7
  v_and_b32 v9, 63, v0
  v_and_b32 v1, 31, v9
  v_lshrrev_b32 v2, 5, v9
  v_lshrrev_b32 v8, 6, v0
  v_lshrrev_b32 v7, 1, v8
  v_and_b32 v8, 1, v8

  v_lshlrev_b32 v15, 3, v2
  v_lshl_add_u32 v15, v8, 7, v15
  v_lshl_add_u32 v14, v7, 6, v1
  v_lshl_add_u32 v14, v14, 10, v15
  s_mov_b32 s60, 32768

  v_and_b32 v9, 63, v0
  v_and_b32 v1, 31, v9
  v_lshrrev_b32 v2, 5, v9
  v_lshrrev_b32 v8, 6, v0
  v_lshrrev_b32 v7, 1, v8
  v_and_b32 v8, 1, v8

  v_lshl_add_u32 v3, v7, 6, v1
  v_mul_u32_u24 v3, 272, v3
  v_lshlrev_b32 v4, 3, v2
  v_lshl_add_u32 v4, v8, 7, v4
  v_add_u32 v3, v3, v4
  v_lshrrev_b32 v5, 4, v0
  v_and_b32 v6, 15, v0
  v_mul_u32_u24 v4, 272, v5
  v_lshl_add_u32 v4, v6, 4, v4
  v_mul_u32_u24 v5, 1024, v5
  v_lshl_add_u32 v5, v6, 4, v5

  buffer_load_dwordx2 v[18:19], v15, s[56:59], 0 offen offset:0
  buffer_load_dwordx2 v[30:31], v14, s[64:67], 0 offen offset:0
  s_waitcnt vmcnt(0)
  v_cvt_pk_bf16_f32 v20, v80, v81
  v_cvt_pk_bf16_f32 v21, v82, v83
  v_lshlrev_b32 v22, 16, v20
  v_lshlrev_b32 v26, 16, v18
  v_and_b32 v23, 0xffff0000, v20
  v_and_b32 v27, 0xffff0000, v18
  v_lshlrev_b32 v24, 16, v21
  v_lshlrev_b32 v28, 16, v19
  v_and_b32 v25, 0xffff0000, v21
  v_and_b32 v29, 0xffff0000, v19
  v_add_f32 v22, v22, v26
  v_add_f32 v23, v23, v27
  v_add_f32 v24, v24, v28
  v_add_f32 v25, v25, v29
  v_cvt_pk_bf16_f32 v20, v22, v23
  v_cvt_pk_bf16_f32 v21, v24, v25
  v_lshlrev_b32 v22, 16, v20
  v_lshlrev_b32 v26, 16, v30
  v_and_b32 v23, 0xffff0000, v20
  v_and_b32 v27, 0xffff0000, v30
  v_lshlrev_b32 v24, 16, v21
  v_lshlrev_b32 v28, 16, v31
  v_and_b32 v25, 0xffff0000, v21
  v_and_b32 v29, 0xffff0000, v31
  v_add_f32 v80, v22, v26
  v_add_f32 v81, v23, v27
  v_add_f32 v82, v24, v28
  v_add_f32 v83, v25, v29
  v_cvt_pk_bf16_f32 v16, v80, v81
  v_cvt_pk_bf16_f32 v17, v82, v83
  ds_write_b64 v3, v[16:17] offset:0
  buffer_load_dwordx2 v[18:19], v15, s[56:59], 0 offen offset:16
  buffer_load_dwordx2 v[30:31], v14, s[64:67], 0 offen offset:16
  s_waitcnt vmcnt(0)
  v_cvt_pk_bf16_f32 v20, v84, v85
  v_cvt_pk_bf16_f32 v21, v86, v87
  v_lshlrev_b32 v22, 16, v20
  v_lshlrev_b32 v26, 16, v18
  v_and_b32 v23, 0xffff0000, v20
  v_and_b32 v27, 0xffff0000, v18
  v_lshlrev_b32 v24, 16, v21
  v_lshlrev_b32 v28, 16, v19
  v_and_b32 v25, 0xffff0000, v21
  v_and_b32 v29, 0xffff0000, v19
  v_add_f32 v22, v22, v26
  v_add_f32 v23, v23, v27
  v_add_f32 v24, v24, v28
  v_add_f32 v25, v25, v29
  v_cvt_pk_bf16_f32 v20, v22, v23
  v_cvt_pk_bf16_f32 v21, v24, v25
  v_lshlrev_b32 v22, 16, v20
  v_lshlrev_b32 v26, 16, v30
  v_and_b32 v23, 0xffff0000, v20
  v_and_b32 v27, 0xffff0000, v30
  v_lshlrev_b32 v24, 16, v21
  v_lshlrev_b32 v28, 16, v31
  v_and_b32 v25, 0xffff0000, v21
  v_and_b32 v29, 0xffff0000, v31
  v_add_f32 v84, v22, v26
  v_add_f32 v85, v23, v27
  v_add_f32 v86, v24, v28
  v_add_f32 v87, v25, v29
  v_cvt_pk_bf16_f32 v16, v84, v85
  v_cvt_pk_bf16_f32 v17, v86, v87
  ds_write_b64 v3, v[16:17] offset:16
  buffer_load_dwordx2 v[18:19], v15, s[56:59], 0 offen offset:32
  buffer_load_dwordx2 v[30:31], v14, s[64:67], 0 offen offset:32
  s_waitcnt vmcnt(0)
  v_cvt_pk_bf16_f32 v20, v88, v89
  v_cvt_pk_bf16_f32 v21, v90, v91
  v_lshlrev_b32 v22, 16, v20
  v_lshlrev_b32 v26, 16, v18
  v_and_b32 v23, 0xffff0000, v20
  v_and_b32 v27, 0xffff0000, v18
  v_lshlrev_b32 v24, 16, v21
  v_lshlrev_b32 v28, 16, v19
  v_and_b32 v25, 0xffff0000, v21
  v_and_b32 v29, 0xffff0000, v19
  v_add_f32 v22, v22, v26
  v_add_f32 v23, v23, v27
  v_add_f32 v24, v24, v28
  v_add_f32 v25, v25, v29
  v_cvt_pk_bf16_f32 v20, v22, v23
  v_cvt_pk_bf16_f32 v21, v24, v25
  v_lshlrev_b32 v22, 16, v20
  v_lshlrev_b32 v26, 16, v30
  v_and_b32 v23, 0xffff0000, v20
  v_and_b32 v27, 0xffff0000, v30
  v_lshlrev_b32 v24, 16, v21
  v_lshlrev_b32 v28, 16, v31
  v_and_b32 v25, 0xffff0000, v21
  v_and_b32 v29, 0xffff0000, v31
  v_add_f32 v88, v22, v26
  v_add_f32 v89, v23, v27
  v_add_f32 v90, v24, v28
  v_add_f32 v91, v25, v29
  v_cvt_pk_bf16_f32 v16, v88, v89
  v_cvt_pk_bf16_f32 v17, v90, v91
  ds_write_b64 v3, v[16:17] offset:32
  buffer_load_dwordx2 v[18:19], v15, s[56:59], 0 offen offset:48
  buffer_load_dwordx2 v[30:31], v14, s[64:67], 0 offen offset:48
  s_waitcnt vmcnt(0)
  v_cvt_pk_bf16_f32 v20, v92, v93
  v_cvt_pk_bf16_f32 v21, v94, v95
  v_lshlrev_b32 v22, 16, v20
  v_lshlrev_b32 v26, 16, v18
  v_and_b32 v23, 0xffff0000, v20
  v_and_b32 v27, 0xffff0000, v18
  v_lshlrev_b32 v24, 16, v21
  v_lshlrev_b32 v28, 16, v19
  v_and_b32 v25, 0xffff0000, v21
  v_and_b32 v29, 0xffff0000, v19
  v_add_f32 v22, v22, v26
  v_add_f32 v23, v23, v27
  v_add_f32 v24, v24, v28
  v_add_f32 v25, v25, v29
  v_cvt_pk_bf16_f32 v20, v22, v23
  v_cvt_pk_bf16_f32 v21, v24, v25
  v_lshlrev_b32 v22, 16, v20
  v_lshlrev_b32 v26, 16, v30
  v_and_b32 v23, 0xffff0000, v20
  v_and_b32 v27, 0xffff0000, v30
  v_lshlrev_b32 v24, 16, v21
  v_lshlrev_b32 v28, 16, v31
  v_and_b32 v25, 0xffff0000, v21
  v_and_b32 v29, 0xffff0000, v31
  v_add_f32 v92, v22, v26
  v_add_f32 v93, v23, v27
  v_add_f32 v94, v24, v28
  v_add_f32 v95, v25, v29
  v_cvt_pk_bf16_f32 v16, v92, v93
  v_cvt_pk_bf16_f32 v17, v94, v95
  ds_write_b64 v3, v[16:17] offset:48
  buffer_load_dwordx2 v[18:19], v15, s[56:59], 0 offen offset:0
  buffer_load_dwordx2 v[30:31], v14, s[64:67], s60 offen offset:0
  s_waitcnt vmcnt(0)
  v_cvt_pk_bf16_f32 v20, v96, v97
  v_cvt_pk_bf16_f32 v21, v98, v99
  v_lshlrev_b32 v22, 16, v20
  v_lshlrev_b32 v26, 16, v18
  v_and_b32 v23, 0xffff0000, v20
  v_and_b32 v27, 0xffff0000, v18
  v_lshlrev_b32 v24, 16, v21
  v_lshlrev_b32 v28, 16, v19
  v_and_b32 v25, 0xffff0000, v21
  v_and_b32 v29, 0xffff0000, v19
  v_add_f32 v22, v22, v26
  v_add_f32 v23, v23, v27
  v_add_f32 v24, v24, v28
  v_add_f32 v25, v25, v29
  v_cvt_pk_bf16_f32 v20, v22, v23
  v_cvt_pk_bf16_f32 v21, v24, v25
  v_lshlrev_b32 v22, 16, v20
  v_lshlrev_b32 v26, 16, v30
  v_and_b32 v23, 0xffff0000, v20
  v_and_b32 v27, 0xffff0000, v30
  v_lshlrev_b32 v24, 16, v21
  v_lshlrev_b32 v28, 16, v31
  v_and_b32 v25, 0xffff0000, v21
  v_and_b32 v29, 0xffff0000, v31
  v_add_f32 v96, v22, v26
  v_add_f32 v97, v23, v27
  v_add_f32 v98, v24, v28
  v_add_f32 v99, v25, v29
  v_cvt_pk_bf16_f32 v16, v96, v97
  v_cvt_pk_bf16_f32 v17, v98, v99
  ds_write_b64 v3, v[16:17] offset:8704
  buffer_load_dwordx2 v[18:19], v15, s[56:59], 0 offen offset:16
  buffer_load_dwordx2 v[30:31], v14, s[64:67], s60 offen offset:16
  s_waitcnt vmcnt(0)
  v_cvt_pk_bf16_f32 v20, v100, v101
  v_cvt_pk_bf16_f32 v21, v102, v103
  v_lshlrev_b32 v22, 16, v20
  v_lshlrev_b32 v26, 16, v18
  v_and_b32 v23, 0xffff0000, v20
  v_and_b32 v27, 0xffff0000, v18
  v_lshlrev_b32 v24, 16, v21
  v_lshlrev_b32 v28, 16, v19
  v_and_b32 v25, 0xffff0000, v21
  v_and_b32 v29, 0xffff0000, v19
  v_add_f32 v22, v22, v26
  v_add_f32 v23, v23, v27
  v_add_f32 v24, v24, v28
  v_add_f32 v25, v25, v29
  v_cvt_pk_bf16_f32 v20, v22, v23
  v_cvt_pk_bf16_f32 v21, v24, v25
  v_lshlrev_b32 v22, 16, v20
  v_lshlrev_b32 v26, 16, v30
  v_and_b32 v23, 0xffff0000, v20
  v_and_b32 v27, 0xffff0000, v30
  v_lshlrev_b32 v24, 16, v21
  v_lshlrev_b32 v28, 16, v31
  v_and_b32 v25, 0xffff0000, v21
  v_and_b32 v29, 0xffff0000, v31
  v_add_f32 v100, v22, v26
  v_add_f32 v101, v23, v27
  v_add_f32 v102, v24, v28
  v_add_f32 v103, v25, v29
  v_cvt_pk_bf16_f32 v16, v100, v101
  v_cvt_pk_bf16_f32 v17, v102, v103
  ds_write_b64 v3, v[16:17] offset:8720
  buffer_load_dwordx2 v[18:19], v15, s[56:59], 0 offen offset:32
  buffer_load_dwordx2 v[30:31], v14, s[64:67], s60 offen offset:32
  s_waitcnt vmcnt(0)
  v_cvt_pk_bf16_f32 v20, v104, v105
  v_cvt_pk_bf16_f32 v21, v106, v107
  v_lshlrev_b32 v22, 16, v20
  v_lshlrev_b32 v26, 16, v18
  v_and_b32 v23, 0xffff0000, v20
  v_and_b32 v27, 0xffff0000, v18
  v_lshlrev_b32 v24, 16, v21
  v_lshlrev_b32 v28, 16, v19
  v_and_b32 v25, 0xffff0000, v21
  v_and_b32 v29, 0xffff0000, v19
  v_add_f32 v22, v22, v26
  v_add_f32 v23, v23, v27
  v_add_f32 v24, v24, v28
  v_add_f32 v25, v25, v29
  v_cvt_pk_bf16_f32 v20, v22, v23
  v_cvt_pk_bf16_f32 v21, v24, v25
  v_lshlrev_b32 v22, 16, v20
  v_lshlrev_b32 v26, 16, v30
  v_and_b32 v23, 0xffff0000, v20
  v_and_b32 v27, 0xffff0000, v30
  v_lshlrev_b32 v24, 16, v21
  v_lshlrev_b32 v28, 16, v31
  v_and_b32 v25, 0xffff0000, v21
  v_and_b32 v29, 0xffff0000, v31
  v_add_f32 v104, v22, v26
  v_add_f32 v105, v23, v27
  v_add_f32 v106, v24, v28
  v_add_f32 v107, v25, v29
  v_cvt_pk_bf16_f32 v16, v104, v105
  v_cvt_pk_bf16_f32 v17, v106, v107
  ds_write_b64 v3, v[16:17] offset:8736
  buffer_load_dwordx2 v[18:19], v15, s[56:59], 0 offen offset:48
  buffer_load_dwordx2 v[30:31], v14, s[64:67], s60 offen offset:48
  s_waitcnt vmcnt(0)
  v_cvt_pk_bf16_f32 v20, v108, v109
  v_cvt_pk_bf16_f32 v21, v110, v111
  v_lshlrev_b32 v22, 16, v20
  v_lshlrev_b32 v26, 16, v18
  v_and_b32 v23, 0xffff0000, v20
  v_and_b32 v27, 0xffff0000, v18
  v_lshlrev_b32 v24, 16, v21
  v_lshlrev_b32 v28, 16, v19
  v_and_b32 v25, 0xffff0000, v21
  v_and_b32 v29, 0xffff0000, v19
  v_add_f32 v22, v22, v26
  v_add_f32 v23, v23, v27
  v_add_f32 v24, v24, v28
  v_add_f32 v25, v25, v29
  v_cvt_pk_bf16_f32 v20, v22, v23
  v_cvt_pk_bf16_f32 v21, v24, v25
  v_lshlrev_b32 v22, 16, v20
  v_lshlrev_b32 v26, 16, v30
  v_and_b32 v23, 0xffff0000, v20
  v_and_b32 v27, 0xffff0000, v30
  v_lshlrev_b32 v24, 16, v21
  v_lshlrev_b32 v28, 16, v31
  v_and_b32 v25, 0xffff0000, v21
  v_and_b32 v29, 0xffff0000, v31
  v_add_f32 v108, v22, v26
  v_add_f32 v109, v23, v27
  v_add_f32 v110, v24, v28
  v_add_f32 v111, v25, v29
  v_cvt_pk_bf16_f32 v16, v108, v109
  v_cvt_pk_bf16_f32 v17, v110, v111
  ds_write_b64 v3, v[16:17] offset:8752
  buffer_load_dwordx2 v[18:19], v15, s[56:59], 0 offen offset:64
  buffer_load_dwordx2 v[30:31], v14, s[64:67], 0 offen offset:64
  s_waitcnt vmcnt(0)
  v_cvt_pk_bf16_f32 v20, v112, v113
  v_cvt_pk_bf16_f32 v21, v114, v115
  v_lshlrev_b32 v22, 16, v20
  v_lshlrev_b32 v26, 16, v18
  v_and_b32 v23, 0xffff0000, v20
  v_and_b32 v27, 0xffff0000, v18
  v_lshlrev_b32 v24, 16, v21
  v_lshlrev_b32 v28, 16, v19
  v_and_b32 v25, 0xffff0000, v21
  v_and_b32 v29, 0xffff0000, v19
  v_add_f32 v22, v22, v26
  v_add_f32 v23, v23, v27
  v_add_f32 v24, v24, v28
  v_add_f32 v25, v25, v29
  v_cvt_pk_bf16_f32 v20, v22, v23
  v_cvt_pk_bf16_f32 v21, v24, v25
  v_lshlrev_b32 v22, 16, v20
  v_lshlrev_b32 v26, 16, v30
  v_and_b32 v23, 0xffff0000, v20
  v_and_b32 v27, 0xffff0000, v30
  v_lshlrev_b32 v24, 16, v21
  v_lshlrev_b32 v28, 16, v31
  v_and_b32 v25, 0xffff0000, v21
  v_and_b32 v29, 0xffff0000, v31
  v_add_f32 v112, v22, v26
  v_add_f32 v113, v23, v27
  v_add_f32 v114, v24, v28
  v_add_f32 v115, v25, v29
  v_cvt_pk_bf16_f32 v16, v112, v113
  v_cvt_pk_bf16_f32 v17, v114, v115
  ds_write_b64 v3, v[16:17] offset:64
  buffer_load_dwordx2 v[18:19], v15, s[56:59], 0 offen offset:80
  buffer_load_dwordx2 v[30:31], v14, s[64:67], 0 offen offset:80
  s_waitcnt vmcnt(0)
  v_cvt_pk_bf16_f32 v20, v116, v117
  v_cvt_pk_bf16_f32 v21, v118, v119
  v_lshlrev_b32 v22, 16, v20
  v_lshlrev_b32 v26, 16, v18
  v_and_b32 v23, 0xffff0000, v20
  v_and_b32 v27, 0xffff0000, v18
  v_lshlrev_b32 v24, 16, v21
  v_lshlrev_b32 v28, 16, v19
  v_and_b32 v25, 0xffff0000, v21
  v_and_b32 v29, 0xffff0000, v19
  v_add_f32 v22, v22, v26
  v_add_f32 v23, v23, v27
  v_add_f32 v24, v24, v28
  v_add_f32 v25, v25, v29
  v_cvt_pk_bf16_f32 v20, v22, v23
  v_cvt_pk_bf16_f32 v21, v24, v25
  v_lshlrev_b32 v22, 16, v20
  v_lshlrev_b32 v26, 16, v30
  v_and_b32 v23, 0xffff0000, v20
  v_and_b32 v27, 0xffff0000, v30
  v_lshlrev_b32 v24, 16, v21
  v_lshlrev_b32 v28, 16, v31
  v_and_b32 v25, 0xffff0000, v21
  v_and_b32 v29, 0xffff0000, v31
  v_add_f32 v116, v22, v26
  v_add_f32 v117, v23, v27
  v_add_f32 v118, v24, v28
  v_add_f32 v119, v25, v29
  v_cvt_pk_bf16_f32 v16, v116, v117
  v_cvt_pk_bf16_f32 v17, v118, v119
  ds_write_b64 v3, v[16:17] offset:80
  buffer_load_dwordx2 v[18:19], v15, s[56:59], 0 offen offset:96
  buffer_load_dwordx2 v[30:31], v14, s[64:67], 0 offen offset:96
  s_waitcnt vmcnt(0)
  v_cvt_pk_bf16_f32 v20, v120, v121
  v_cvt_pk_bf16_f32 v21, v122, v123
  v_lshlrev_b32 v22, 16, v20
  v_lshlrev_b32 v26, 16, v18
  v_and_b32 v23, 0xffff0000, v20
  v_and_b32 v27, 0xffff0000, v18
  v_lshlrev_b32 v24, 16, v21
  v_lshlrev_b32 v28, 16, v19
  v_and_b32 v25, 0xffff0000, v21
  v_and_b32 v29, 0xffff0000, v19
  v_add_f32 v22, v22, v26
  v_add_f32 v23, v23, v27
  v_add_f32 v24, v24, v28
  v_add_f32 v25, v25, v29
  v_cvt_pk_bf16_f32 v20, v22, v23
  v_cvt_pk_bf16_f32 v21, v24, v25
  v_lshlrev_b32 v22, 16, v20
  v_lshlrev_b32 v26, 16, v30
  v_and_b32 v23, 0xffff0000, v20
  v_and_b32 v27, 0xffff0000, v30
  v_lshlrev_b32 v24, 16, v21
  v_lshlrev_b32 v28, 16, v31
  v_and_b32 v25, 0xffff0000, v21
  v_and_b32 v29, 0xffff0000, v31
  v_add_f32 v120, v22, v26
  v_add_f32 v121, v23, v27
  v_add_f32 v122, v24, v28
  v_add_f32 v123, v25, v29
  v_cvt_pk_bf16_f32 v16, v120, v121
  v_cvt_pk_bf16_f32 v17, v122, v123
  ds_write_b64 v3, v[16:17] offset:96
  buffer_load_dwordx2 v[18:19], v15, s[56:59], 0 offen offset:112
  buffer_load_dwordx2 v[30:31], v14, s[64:67], 0 offen offset:112
  s_waitcnt vmcnt(0)
  v_cvt_pk_bf16_f32 v20, v124, v125
  v_cvt_pk_bf16_f32 v21, v126, v127
  v_lshlrev_b32 v22, 16, v20
  v_lshlrev_b32 v26, 16, v18
  v_and_b32 v23, 0xffff0000, v20
  v_and_b32 v27, 0xffff0000, v18
  v_lshlrev_b32 v24, 16, v21
  v_lshlrev_b32 v28, 16, v19
  v_and_b32 v25, 0xffff0000, v21
  v_and_b32 v29, 0xffff0000, v19
  v_add_f32 v22, v22, v26
  v_add_f32 v23, v23, v27
  v_add_f32 v24, v24, v28
  v_add_f32 v25, v25, v29
  v_cvt_pk_bf16_f32 v20, v22, v23
  v_cvt_pk_bf16_f32 v21, v24, v25
  v_lshlrev_b32 v22, 16, v20
  v_lshlrev_b32 v26, 16, v30
  v_and_b32 v23, 0xffff0000, v20
  v_and_b32 v27, 0xffff0000, v30
  v_lshlrev_b32 v24, 16, v21
  v_lshlrev_b32 v28, 16, v31
  v_and_b32 v25, 0xffff0000, v21
  v_and_b32 v29, 0xffff0000, v31
  v_add_f32 v124, v22, v26
  v_add_f32 v125, v23, v27
  v_add_f32 v126, v24, v28
  v_add_f32 v127, v25, v29
  v_cvt_pk_bf16_f32 v16, v124, v125
  v_cvt_pk_bf16_f32 v17, v126, v127
  ds_write_b64 v3, v[16:17] offset:112
  buffer_load_dwordx2 v[18:19], v15, s[56:59], 0 offen offset:64
  buffer_load_dwordx2 v[30:31], v14, s[64:67], s60 offen offset:64
  s_waitcnt vmcnt(0)
  v_cvt_pk_bf16_f32 v20, v128, v129
  v_cvt_pk_bf16_f32 v21, v130, v131
  v_lshlrev_b32 v22, 16, v20
  v_lshlrev_b32 v26, 16, v18
  v_and_b32 v23, 0xffff0000, v20
  v_and_b32 v27, 0xffff0000, v18
  v_lshlrev_b32 v24, 16, v21
  v_lshlrev_b32 v28, 16, v19
  v_and_b32 v25, 0xffff0000, v21
  v_and_b32 v29, 0xffff0000, v19
  v_add_f32 v22, v22, v26
  v_add_f32 v23, v23, v27
  v_add_f32 v24, v24, v28
  v_add_f32 v25, v25, v29
  v_cvt_pk_bf16_f32 v20, v22, v23
  v_cvt_pk_bf16_f32 v21, v24, v25
  v_lshlrev_b32 v22, 16, v20
  v_lshlrev_b32 v26, 16, v30
  v_and_b32 v23, 0xffff0000, v20
  v_and_b32 v27, 0xffff0000, v30
  v_lshlrev_b32 v24, 16, v21
  v_lshlrev_b32 v28, 16, v31
  v_and_b32 v25, 0xffff0000, v21
  v_and_b32 v29, 0xffff0000, v31
  v_add_f32 v128, v22, v26
  v_add_f32 v129, v23, v27
  v_add_f32 v130, v24, v28
  v_add_f32 v131, v25, v29
  v_cvt_pk_bf16_f32 v16, v128, v129
  v_cvt_pk_bf16_f32 v17, v130, v131
  ds_write_b64 v3, v[16:17] offset:8768
  buffer_load_dwordx2 v[18:19], v15, s[56:59], 0 offen offset:80
  buffer_load_dwordx2 v[30:31], v14, s[64:67], s60 offen offset:80
  s_waitcnt vmcnt(0)
  v_cvt_pk_bf16_f32 v20, v132, v133
  v_cvt_pk_bf16_f32 v21, v134, v135
  v_lshlrev_b32 v22, 16, v20
  v_lshlrev_b32 v26, 16, v18
  v_and_b32 v23, 0xffff0000, v20
  v_and_b32 v27, 0xffff0000, v18
  v_lshlrev_b32 v24, 16, v21
  v_lshlrev_b32 v28, 16, v19
  v_and_b32 v25, 0xffff0000, v21
  v_and_b32 v29, 0xffff0000, v19
  v_add_f32 v22, v22, v26
  v_add_f32 v23, v23, v27
  v_add_f32 v24, v24, v28
  v_add_f32 v25, v25, v29
  v_cvt_pk_bf16_f32 v20, v22, v23
  v_cvt_pk_bf16_f32 v21, v24, v25
  v_lshlrev_b32 v22, 16, v20
  v_lshlrev_b32 v26, 16, v30
  v_and_b32 v23, 0xffff0000, v20
  v_and_b32 v27, 0xffff0000, v30
  v_lshlrev_b32 v24, 16, v21
  v_lshlrev_b32 v28, 16, v31
  v_and_b32 v25, 0xffff0000, v21
  v_and_b32 v29, 0xffff0000, v31
  v_add_f32 v132, v22, v26
  v_add_f32 v133, v23, v27
  v_add_f32 v134, v24, v28
  v_add_f32 v135, v25, v29
  v_cvt_pk_bf16_f32 v16, v132, v133
  v_cvt_pk_bf16_f32 v17, v134, v135
  ds_write_b64 v3, v[16:17] offset:8784
  buffer_load_dwordx2 v[18:19], v15, s[56:59], 0 offen offset:96
  buffer_load_dwordx2 v[30:31], v14, s[64:67], s60 offen offset:96
  s_waitcnt vmcnt(0)
  v_cvt_pk_bf16_f32 v20, v136, v137
  v_cvt_pk_bf16_f32 v21, v138, v139
  v_lshlrev_b32 v22, 16, v20
  v_lshlrev_b32 v26, 16, v18
  v_and_b32 v23, 0xffff0000, v20
  v_and_b32 v27, 0xffff0000, v18
  v_lshlrev_b32 v24, 16, v21
  v_lshlrev_b32 v28, 16, v19
  v_and_b32 v25, 0xffff0000, v21
  v_and_b32 v29, 0xffff0000, v19
  v_add_f32 v22, v22, v26
  v_add_f32 v23, v23, v27
  v_add_f32 v24, v24, v28
  v_add_f32 v25, v25, v29
  v_cvt_pk_bf16_f32 v20, v22, v23
  v_cvt_pk_bf16_f32 v21, v24, v25
  v_lshlrev_b32 v22, 16, v20
  v_lshlrev_b32 v26, 16, v30
  v_and_b32 v23, 0xffff0000, v20
  v_and_b32 v27, 0xffff0000, v30
  v_lshlrev_b32 v24, 16, v21
  v_lshlrev_b32 v28, 16, v31
  v_and_b32 v25, 0xffff0000, v21
  v_and_b32 v29, 0xffff0000, v31
  v_add_f32 v136, v22, v26
  v_add_f32 v137, v23, v27
  v_add_f32 v138, v24, v28
  v_add_f32 v139, v25, v29
  v_cvt_pk_bf16_f32 v16, v136, v137
  v_cvt_pk_bf16_f32 v17, v138, v139
  ds_write_b64 v3, v[16:17] offset:8800
  buffer_load_dwordx2 v[18:19], v15, s[56:59], 0 offen offset:112
  buffer_load_dwordx2 v[30:31], v14, s[64:67], s60 offen offset:112
  s_waitcnt vmcnt(0)
  v_cvt_pk_bf16_f32 v20, v140, v141
  v_cvt_pk_bf16_f32 v21, v142, v143
  v_lshlrev_b32 v22, 16, v20
  v_lshlrev_b32 v26, 16, v18
  v_and_b32 v23, 0xffff0000, v20
  v_and_b32 v27, 0xffff0000, v18
  v_lshlrev_b32 v24, 16, v21
  v_lshlrev_b32 v28, 16, v19
  v_and_b32 v25, 0xffff0000, v21
  v_and_b32 v29, 0xffff0000, v19
  v_add_f32 v22, v22, v26
  v_add_f32 v23, v23, v27
  v_add_f32 v24, v24, v28
  v_add_f32 v25, v25, v29
  v_cvt_pk_bf16_f32 v20, v22, v23
  v_cvt_pk_bf16_f32 v21, v24, v25
  v_lshlrev_b32 v22, 16, v20
  v_lshlrev_b32 v26, 16, v30
  v_and_b32 v23, 0xffff0000, v20
  v_and_b32 v27, 0xffff0000, v30
  v_lshlrev_b32 v24, 16, v21
  v_lshlrev_b32 v28, 16, v31
  v_and_b32 v25, 0xffff0000, v21
  v_and_b32 v29, 0xffff0000, v31
  v_add_f32 v140, v22, v26
  v_add_f32 v141, v23, v27
  v_add_f32 v142, v24, v28
  v_add_f32 v143, v25, v29
  v_cvt_pk_bf16_f32 v16, v140, v141
  v_cvt_pk_bf16_f32 v17, v142, v143
  ds_write_b64 v3, v[16:17] offset:8816
  s_waitcnt lgkmcnt(0)
  s_barrier
  ds_read_b128 v[80:83], v4 offset:0
  ds_read_b128 v[84:87], v4 offset:4352
  ds_read_b128 v[88:91], v4 offset:8704
  ds_read_b128 v[92:95], v4 offset:13056
  ds_read_b128 v[96:99], v4 offset:17408
  ds_read_b128 v[100:103], v4 offset:21760
  ds_read_b128 v[104:107], v4 offset:26112
  ds_read_b128 v[108:111], v4 offset:30464
  s_mov_b32 s23, 0
  s_waitcnt lgkmcnt(7)
  buffer_store_dwordx4 v[80:83], v5, s[12:15], s23 offen
  s_mov_b32 s23, 16384
  s_waitcnt lgkmcnt(6)
  buffer_store_dwordx4 v[84:87], v5, s[12:15], s23 offen
  s_mov_b32 s23, 32768
  s_waitcnt lgkmcnt(5)
  buffer_store_dwordx4 v[88:91], v5, s[12:15], s23 offen
  s_mov_b32 s23, 49152
  s_waitcnt lgkmcnt(4)
  buffer_store_dwordx4 v[92:95], v5, s[12:15], s23 offen
  s_mov_b32 s23, 65536
  s_waitcnt lgkmcnt(3)
  buffer_store_dwordx4 v[96:99], v5, s[12:15], s23 offen
  s_mov_b32 s23, 81920
  s_waitcnt lgkmcnt(2)
  buffer_store_dwordx4 v[100:103], v5, s[12:15], s23 offen
  s_mov_b32 s23, 98304
  s_waitcnt lgkmcnt(1)
  buffer_store_dwordx4 v[104:107], v5, s[12:15], s23 offen
  s_mov_b32 s23, 114688
  s_waitcnt lgkmcnt(0)
  buffer_store_dwordx4 v[108:111], v5, s[12:15], s23 offen
L_ffn2_kernel_done:
  s_endpgm
.section .rodata,"a"
.p2align 6
.amdhsa_kernel ffn2_kernel
  .amdhsa_next_free_vgpr 152
  .amdhsa_next_free_sgpr 96
  .amdhsa_accum_offset 152
  .amdhsa_group_segment_fixed_size 0
  .amdhsa_kernarg_size 112
  .amdhsa_user_sgpr_count 2
  .amdhsa_user_sgpr_kernarg_segment_ptr 1
  .amdhsa_system_sgpr_workgroup_id_x 1
.end_amdhsa_kernel
```
